```python
import torch

def _softmax(x, axis=-1):
    return torch.softmax(x, dim=axis)
def _gelu(x):
    return torch.nn.functional.gelu(x, approximate="tanh")
def _silu(x):
    return torch.nn.functional.silu(x)
def _sigmoid(x):
    return torch.sigmoid(x)
def _layernorm(x, axis=-1, eps=1e-5):
    m = x.mean(dim=axis, keepdim=True)
    v = x.var(dim=axis, keepdim=True, unbiased=False)
    return (x - m) / torch.sqrt(v + eps)
def _scatter_add(tgt, idx, src, axis=0):
    return tgt.clone().index_add_(axis, idx, src)
def _segment_sum(src, seg, n):
    out = torch.zeros((n,) + src.shape[1:], dtype=src.dtype)
    return out.index_add_(0, seg, src)
def _pad(x, pw):
    flat = tuple(v for pair in reversed(pw) for v in pair)
    return torch.nn.functional.pad(x, flat)

kernel_name = 'standalone__dense_activation_relu__prompt'

def setup_inputs():

    _w = (lambda a: (lambda t: t.to(torch.bfloat16) if t.is_floating_point() else t)(torch.as_tensor(a)))
    B, S, D, Dff = 1, 2048, 448, 1792
    return {
        "x": _w((lambda *s: torch.randn(*s, dtype=torch.bfloat16) * 0.05)(B, S, D)),
        "w1": _w((lambda *s: torch.randn(*s, dtype=torch.bfloat16) * 0.05)(D, Dff)),
        "w2": _w((lambda *s: torch.randn(*s, dtype=torch.bfloat16) * 0.05)(Dff, D)),
    }

def reference(x, w1, w2):
    h = torch.einsum("bsd,df->bsf", x, w1)
    zero = torch.zeros_like(h)
    h = torch.maximum(h, zero)
    return torch.einsum("bsf,fd->bsd", h, w2)
```

```asm
; @launch grid=(224,1,1) block=(512,1,1) lds=163840
.amdgcn_target "amdgcn-amd-amdhsa--gfx950"
.text
.globl standalone__dense_activation_relu__prompt_kernel
.p2align 8
.type standalone__dense_activation_relu__prompt_kernel,@function
standalone__dense_activation_relu__prompt_kernel:
  s_load_dwordx8 s[36:43], s[0:1], 0
  s_load_dwordx4 s[44:47], s[0:1], 32
  v_lshrrev_b32 v2, 6, v0
  v_and_b32 v1, 63, v0
  s_cmp_ge_u32 s2, 224
  s_cbranch_scc1 L_end
  v_readfirstlane_b32 s3, v2
  s_and_b32 s48, s2, 7
  s_lshr_b32 s49, s2, 3
  s_mul_i32 s50, s49, 37
  s_lshr_b32 s50, s50, 8
  s_mul_i32 s51, s50, 7
  s_sub_u32 s51, s49, s51
  s_lshr_b32 s52, s48, 1
  s_lshl_b32 s52, s52, 2
  s_add_u32 s52, s52, s50
  s_and_b32 s53, s48, 1
  s_mul_i32 s53, s53, 7
  s_add_u32 s53, s53, s51
  s_cmp_lt_u32 s3, 4
  s_cbranch_scc1 L_compute
  s_add_u32 s56, s50, s51
  s_and_b32 s56, s56, 1
  s_lshl_b32 s56, s56, 2
  s_add_u32 s56, s56, s48
  s_sub_u32 s59, s56, 7
  s_cselect_b32 s56, s56, s59
  s_and_b32 s57, s3, 3
  v_lshrrev_b32 v2, 3, v1
  v_mul_u32_u24 v2, 896, v2
  v_lshrrev_b32 v3, 4, v1
  v_and_b32 v16, 7, v1
  v_xor_b32 v16, v3, v16
  v_xor_b32 v17, 4, v16
  v_lshl_add_u32 v4, v16, 4, v2
  v_lshl_add_u32 v5, v17, 4, v2
  v_add_u32 v6, 12288, v4
  v_add_u32 v7, 18432, v5
  v_add_u32 v5, 6144, v5
  v_bfe_u32 v2, v1, 2, 2
  v_mul_u32_u24 v2, 3584, v2
  v_lshl_add_u32 v2, v3, 6, v2
  v_and_b32 v17, 3, v1
  v_lshl_add_u32 v8, v17, 4, v2
  v_add_u32 v9, 13312, v8
  v_add_u32 v10, 26624, v8
  v_add_u32 v11, 39936, v8
  s_lshl_b32 s60, s52, 2
  s_add_u32 s60, s60, s57
  s_mul_i32 s60, s60, 28672
  s_lshl_b32 s59, s56, 7
  s_add_u32 s60, s60, s59
  s_lshl_b32 s61, s56, 2
  s_add_u32 s61, s61, s57
  s_mul_i32 s61, s61, 57344
  s_lshl_b32 s59, s53, 8
  s_add_u32 s61, s61, s59
  s_mov_b32 s63, s56
  s_lshl_b32 s64, s57, 12
  s_mov_b32 s10, 1835008
  s_mov_b32 s11, 0x20000
  s_mov_b32 s14, 1605632
  s_mov_b32 s15, 0x20000
  s_waitcnt lgkmcnt(0)
  s_mov_b32 s8, s36
  s_mov_b32 s9, s37
  s_mov_b32 s12, s38
  s_mov_b32 s13, s39
  s_add_u32 m0, s64, 0
  s_nop 0
  buffer_load_dwordx4 v4, s[8:11], s60 offen offset:0 lds
  buffer_load_dwordx4 v5, s[8:11], s60 offen offset:1024 lds
  buffer_load_dwordx4 v6, s[8:11], s60 offen offset:2048 lds
  buffer_load_dwordx4 v7, s[8:11], s60 offen offset:3072 lds
  s_add_u32 m0, s64, 16384
  s_nop 0
  buffer_load_dwordx4 v8, s[12:15], s61 offen offset:0 lds
  buffer_load_dwordx4 v9, s[12:15], s61 offen offset:1024 lds
  buffer_load_dwordx4 v10, s[12:15], s61 offen offset:2048 lds
  buffer_load_dwordx4 v11, s[12:15], s61 offen offset:3072 lds
  s_add_u32 s63, s63, 1
  s_cmp_eq_u32 s63, 7
  s_cselect_b32 s63, 0, s63
  s_cselect_b32 s59, 4294966400, 0
  s_cselect_b32 s62, 4293361664, 0
  s_add_u32 s60, s60, 128
  s_add_u32 s61, s61, 229376
  s_add_u32 s60, s60, s59
  s_add_u32 s61, s61, s62
  s_add_u32 m0, s64, 32768
  s_nop 0
  buffer_load_dwordx4 v4, s[8:11], s60 offen offset:0 lds
  buffer_load_dwordx4 v5, s[8:11], s60 offen offset:1024 lds
  buffer_load_dwordx4 v6, s[8:11], s60 offen offset:2048 lds
  buffer_load_dwordx4 v7, s[8:11], s60 offen offset:3072 lds
  s_lshr_b32 s55, s50, 1
  s_mul_i32 s55, s55, 4
  s_add_u32 s55, s55, s48
  s_sub_u32 s59, s55, 7
  s_cselect_b32 s55, s55, s59
  v_lshrrev_b32 v2, 5, v1
  v_bfe_u32 v3, v1, 2, 2
  v_lshl_add_u32 v2, v2, 2, v3
  v_mul_u32_u24 v2, 896, v2
  v_and_b32 v3, 3, v1
  v_lshl_add_u32 v2, v3, 4, v2
  v_bfe_u32 v3, v1, 4, 1
  v_lshl_add_u32 v18, v3, 6, v2
  v_xor_b32 v3, 1, v3
  v_lshl_add_u32 v19, v3, 6, v2
  s_and_b32 s35, s57, 1
  s_lshl_b32 s35, s35, 1
  s_add_u32 s35, s35, s51
  s_add_u32 s59, s35, 0
  s_and_b32 s62, s59, 1
  s_bfe_u32 s59, s59, 0x10001
  s_lshl_b32 s59, s59, 2
  s_add_u32 s59, s59, s62
  s_mul_i32 s59, s59, 14336
  v_add_u32 v12, s59, v18
  v_add_u32 v20, s59, v19
  v_add_u32 v13, 7168, v12
  v_add_u32 v21, 7168, v20
  s_add_u32 s59, s35, 1
  s_and_b32 s62, s59, 1
  s_bfe_u32 s59, s59, 0x10001
  s_lshl_b32 s59, s59, 2
  s_add_u32 s59, s59, s62
  s_mul_i32 s59, s59, 14336
  v_add_u32 v14, s59, v18
  v_add_u32 v22, s59, v19
  v_add_u32 v15, 7168, v14
  v_add_u32 v23, 7168, v22
  s_lshr_b32 s65, s57, 1
  s_lshl_b32 s58, s51, 7
  s_mov_b32 s16, s40
  s_mov_b32 s17, s41
  s_mov_b32 s18, 1605632
  s_mov_b32 s19, 0x20000
  s_waitcnt vmcnt(8)
  s_add_u32 m0, s64, 49152
  s_nop 0
  buffer_load_dwordx4 v8, s[12:15], s61 offen offset:0 lds
  buffer_load_dwordx4 v9, s[12:15], s61 offen offset:1024 lds
  buffer_load_dwordx4 v10, s[12:15], s61 offen offset:2048 lds
  buffer_load_dwordx4 v11, s[12:15], s61 offen offset:3072 lds
  s_add_u32 s63, s63, 1
  s_cmp_eq_u32 s63, 7
  s_cselect_b32 s63, 0, s63
  s_cselect_b32 s59, 4294966400, 0
  s_cselect_b32 s62, 4293361664, 0
  s_add_u32 s60, s60, 128
  s_add_u32 s61, s61, 229376
  s_add_u32 s60, s60, s59
  s_add_u32 s61, s61, s62
  s_waitcnt vmcnt(8)
  s_barrier
  s_add_u32 m0, s64, 65536
  s_nop 0
  buffer_load_dwordx4 v4, s[8:11], s60 offen offset:0 lds
  buffer_load_dwordx4 v5, s[8:11], s60 offen offset:1024 lds
  buffer_load_dwordx4 v6, s[8:11], s60 offen offset:2048 lds
  buffer_load_dwordx4 v7, s[8:11], s60 offen offset:3072 lds
  s_waitcnt vmcnt(8)
  s_add_u32 m0, s64, 81920
  s_nop 0
  buffer_load_dwordx4 v8, s[12:15], s61 offen offset:0 lds
  buffer_load_dwordx4 v9, s[12:15], s61 offen offset:1024 lds
  buffer_load_dwordx4 v10, s[12:15], s61 offen offset:2048 lds
  buffer_load_dwordx4 v11, s[12:15], s61 offen offset:3072 lds
  s_add_u32 s63, s63, 1
  s_cmp_eq_u32 s63, 7
  s_cselect_b32 s63, 0, s63
  s_cselect_b32 s59, 4294966400, 0
  s_cselect_b32 s62, 4293361664, 0
  s_add_u32 s60, s60, 128
  s_add_u32 s61, s61, 229376
  s_add_u32 s60, s60, s59
  s_add_u32 s61, s61, s62
  s_waitcnt vmcnt(8)
  s_barrier
  s_add_u32 m0, s64, 98304
  s_nop 0
  buffer_load_dwordx4 v4, s[8:11], s60 offen offset:0 lds
  buffer_load_dwordx4 v5, s[8:11], s60 offen offset:1024 lds
  buffer_load_dwordx4 v6, s[8:11], s60 offen offset:2048 lds
  buffer_load_dwordx4 v7, s[8:11], s60 offen offset:3072 lds
  s_waitcnt vmcnt(8)
  s_add_u32 m0, s64, 114688
  s_nop 0
  buffer_load_dwordx4 v8, s[12:15], s61 offen offset:0 lds
  buffer_load_dwordx4 v9, s[12:15], s61 offen offset:1024 lds
  buffer_load_dwordx4 v10, s[12:15], s61 offen offset:2048 lds
  buffer_load_dwordx4 v11, s[12:15], s61 offen offset:3072 lds
  s_add_u32 s63, s63, 1
  s_cmp_eq_u32 s63, 7
  s_cselect_b32 s63, 0, s63
  s_cselect_b32 s59, 4294966400, 0
  s_cselect_b32 s62, 4293361664, 0
  s_add_u32 s60, s60, 128
  s_add_u32 s61, s61, 229376
  s_add_u32 s60, s60, s59
  s_add_u32 s61, s61, s62
  s_waitcnt vmcnt(8)
  s_barrier
  s_add_u32 m0, s64, 131072
  s_nop 0
  buffer_load_dwordx4 v4, s[8:11], s60 offen offset:0 lds
  buffer_load_dwordx4 v5, s[8:11], s60 offen offset:1024 lds
  buffer_load_dwordx4 v6, s[8:11], s60 offen offset:2048 lds
  buffer_load_dwordx4 v7, s[8:11], s60 offen offset:3072 lds
  s_waitcnt vmcnt(8)
  s_add_u32 m0, s64, 147456
  s_nop 0
  buffer_load_dwordx4 v8, s[12:15], s61 offen offset:0 lds
  buffer_load_dwordx4 v9, s[12:15], s61 offen offset:1024 lds
  buffer_load_dwordx4 v10, s[12:15], s61 offen offset:2048 lds
  buffer_load_dwordx4 v11, s[12:15], s61 offen offset:3072 lds
  s_add_u32 s63, s63, 1
  s_cmp_eq_u32 s63, 7
  s_cselect_b32 s63, 0, s63
  s_cselect_b32 s59, 4294966400, 0
  s_cselect_b32 s62, 4293361664, 0
  s_add_u32 s60, s60, 128
  s_add_u32 s61, s61, 229376
  s_add_u32 s60, s60, s59
  s_add_u32 s61, s61, s62
  s_waitcnt vmcnt(8)
  s_add_u32 m0, s64, 0
  s_nop 0
  buffer_load_dwordx4 v4, s[8:11], s60 offen offset:0 lds
  buffer_load_dwordx4 v5, s[8:11], s60 offen offset:1024 lds
  buffer_load_dwordx4 v6, s[8:11], s60 offen offset:2048 lds
  buffer_load_dwordx4 v7, s[8:11], s60 offen offset:3072 lds
  s_barrier
  s_waitcnt vmcnt(8)
  s_add_u32 m0, s64, 16384
  s_nop 0
  buffer_load_dwordx4 v8, s[12:15], s61 offen offset:0 lds
  buffer_load_dwordx4 v9, s[12:15], s61 offen offset:1024 lds
  buffer_load_dwordx4 v10, s[12:15], s61 offen offset:2048 lds
  buffer_load_dwordx4 v11, s[12:15], s61 offen offset:3072 lds
  s_add_u32 s63, s63, 1
  s_cmp_eq_u32 s63, 7
  s_cselect_b32 s63, 0, s63
  s_cselect_b32 s59, 4294966400, 0
  s_cselect_b32 s62, 4293361664, 0
  s_add_u32 s60, s60, 128
  s_add_u32 s61, s61, 229376
  s_add_u32 s60, s60, s59
  s_add_u32 s61, s61, s62
  s_waitcnt vmcnt(8)
  s_add_u32 m0, s64, 32768
  s_nop 0
  buffer_load_dwordx4 v4, s[8:11], s60 offen offset:0 lds
  buffer_load_dwordx4 v5, s[8:11], s60 offen offset:1024 lds
  buffer_load_dwordx4 v6, s[8:11], s60 offen offset:2048 lds
  buffer_load_dwordx4 v7, s[8:11], s60 offen offset:3072 lds
  s_barrier
  s_waitcnt vmcnt(8)
  s_add_u32 m0, s64, 49152
  s_nop 0
  buffer_load_dwordx4 v8, s[12:15], s61 offen offset:0 lds
  buffer_load_dwordx4 v9, s[12:15], s61 offen offset:1024 lds
  buffer_load_dwordx4 v10, s[12:15], s61 offen offset:2048 lds
  buffer_load_dwordx4 v11, s[12:15], s61 offen offset:3072 lds
  s_waitcnt vmcnt(8)
  s_add_u32 s62, s65, 0
  s_sub_u32 s59, s62, 7
  s_cselect_b32 s62, s62, s59
  s_cselect_b32 s60, 0, 28672
  s_add_u32 s62, s62, s55
  s_sub_u32 s59, s62, 7
  s_cselect_b32 s62, s62, s59
  s_mul_i32 s62, s62, 114688
  s_add_u32 s60, s60, s62
  s_add_u32 s60, s60, s58
  s_add_u32 s61, s60, 802816
  s_add_u32 m0, s64, 65536
  s_nop 0
  buffer_load_dwordx4 v12, s[16:19], s60 offen lds
  s_add_u32 m0, s64, 66560
  s_nop 0
  buffer_load_dwordx4 v13, s[16:19], s60 offen lds
  s_add_u32 m0, s64, 67584
  s_nop 0
  buffer_load_dwordx4 v14, s[16:19], s60 offen lds
  s_add_u32 m0, s64, 68608
  s_nop 0
  buffer_load_dwordx4 v15, s[16:19], s60 offen lds
  s_barrier
  s_waitcnt vmcnt(8)
  s_add_u32 m0, s64, 81920
  s_nop 0
  buffer_load_dwordx4 v20, s[16:19], s61 offen lds
  s_add_u32 m0, s64, 82944
  s_nop 0
  buffer_load_dwordx4 v21, s[16:19], s61 offen lds
  s_add_u32 m0, s64, 83968
  s_nop 0
  buffer_load_dwordx4 v22, s[16:19], s61 offen lds
  s_add_u32 m0, s64, 84992
  s_nop 0
  buffer_load_dwordx4 v23, s[16:19], s61 offen lds
  s_waitcnt vmcnt(8)
  s_barrier
  s_barrier
  s_add_u32 s62, s65, 2
  s_sub_u32 s59, s62, 7
  s_cselect_b32 s62, s62, s59
  s_cselect_b32 s60, 0, 28672
  s_add_u32 s62, s62, s55
  s_sub_u32 s59, s62, 7
  s_cselect_b32 s62, s62, s59
  s_mul_i32 s62, s62, 114688
  s_add_u32 s60, s60, s62
  s_add_u32 s60, s60, s58
  s_add_u32 s61, s60, 802816
  s_add_u32 m0, s64, 98304
  s_nop 0
  buffer_load_dwordx4 v12, s[16:19], s60 offen lds
  s_add_u32 m0, s64, 99328
  s_nop 0
  buffer_load_dwordx4 v13, s[16:19], s60 offen lds
  s_add_u32 m0, s64, 100352
  s_nop 0
  buffer_load_dwordx4 v14, s[16:19], s60 offen lds
  s_add_u32 m0, s64, 101376
  s_nop 0
  buffer_load_dwordx4 v15, s[16:19], s60 offen lds
  s_waitcnt vmcnt(8)
  s_add_u32 m0, s64, 114688
  s_nop 0
  buffer_load_dwordx4 v20, s[16:19], s61 offen lds
  s_add_u32 m0, s64, 115712
  s_nop 0
  buffer_load_dwordx4 v21, s[16:19], s61 offen lds
  s_add_u32 m0, s64, 116736
  s_nop 0
  buffer_load_dwordx4 v22, s[16:19], s61 offen lds
  s_add_u32 m0, s64, 117760
  s_nop 0
  buffer_load_dwordx4 v23, s[16:19], s61 offen lds
  s_waitcnt vmcnt(8)
  s_add_u32 s62, s65, 4
  s_sub_u32 s59, s62, 7
  s_cselect_b32 s62, s62, s59
  s_cselect_b32 s60, 0, 28672
  s_add_u32 s62, s62, s55
  s_sub_u32 s59, s62, 7
  s_cselect_b32 s62, s62, s59
  s_mul_i32 s62, s62, 114688
  s_add_u32 s60, s60, s62
  s_add_u32 s60, s60, s58
  s_add_u32 s61, s60, 802816
  s_add_u32 m0, s64, 131072
  s_nop 0
  buffer_load_dwordx4 v12, s[16:19], s60 offen lds
  s_add_u32 m0, s64, 132096
  s_nop 0
  buffer_load_dwordx4 v13, s[16:19], s60 offen lds
  s_add_u32 m0, s64, 133120
  s_nop 0
  buffer_load_dwordx4 v14, s[16:19], s60 offen lds
  s_add_u32 m0, s64, 134144
  s_nop 0
  buffer_load_dwordx4 v15, s[16:19], s60 offen lds
  s_waitcnt vmcnt(8)
  s_add_u32 m0, s64, 147456
  s_nop 0
  buffer_load_dwordx4 v20, s[16:19], s61 offen lds
  s_add_u32 m0, s64, 148480
  s_nop 0
  buffer_load_dwordx4 v21, s[16:19], s61 offen lds
  s_add_u32 m0, s64, 149504
  s_nop 0
  buffer_load_dwordx4 v22, s[16:19], s61 offen lds
  s_add_u32 m0, s64, 150528
  s_nop 0
  buffer_load_dwordx4 v23, s[16:19], s61 offen lds
  s_waitcnt vmcnt(8)
  s_add_u32 s62, s65, 6
  s_sub_u32 s59, s62, 7
  s_cselect_b32 s62, s62, s59
  s_cselect_b32 s60, 0, 28672
  s_add_u32 s62, s62, s55
  s_sub_u32 s59, s62, 7
  s_cselect_b32 s62, s62, s59
  s_mul_i32 s62, s62, 114688
  s_add_u32 s60, s60, s62
  s_add_u32 s60, s60, s58
  s_add_u32 s61, s60, 802816
  s_add_u32 m0, s64, 0
  s_nop 0
  buffer_load_dwordx4 v12, s[16:19], s60 offen lds
  s_add_u32 m0, s64, 1024
  s_nop 0
  buffer_load_dwordx4 v13, s[16:19], s60 offen lds
  s_add_u32 m0, s64, 2048
  s_nop 0
  buffer_load_dwordx4 v14, s[16:19], s60 offen lds
  s_add_u32 m0, s64, 3072
  s_nop 0
  buffer_load_dwordx4 v15, s[16:19], s60 offen lds
  s_waitcnt vmcnt(8)
  s_add_u32 m0, s64, 16384
  s_nop 0
  buffer_load_dwordx4 v20, s[16:19], s61 offen lds
  s_add_u32 m0, s64, 17408
  s_nop 0
  buffer_load_dwordx4 v21, s[16:19], s61 offen lds
  s_add_u32 m0, s64, 18432
  s_nop 0
  buffer_load_dwordx4 v22, s[16:19], s61 offen lds
  s_add_u32 m0, s64, 19456
  s_nop 0
  buffer_load_dwordx4 v23, s[16:19], s61 offen lds
  s_waitcnt vmcnt(8)
  s_add_u32 s62, s65, 8
  s_sub_u32 s59, s62, 7
  s_cselect_b32 s62, s62, s59
  s_cselect_b32 s60, 0, 28672
  s_add_u32 s62, s62, s55
  s_sub_u32 s59, s62, 7
  s_cselect_b32 s62, s62, s59
  s_mul_i32 s62, s62, 114688
  s_add_u32 s60, s60, s62
  s_add_u32 s60, s60, s58
  s_add_u32 s61, s60, 802816
  s_add_u32 m0, s64, 32768
  s_nop 0
  buffer_load_dwordx4 v12, s[16:19], s60 offen lds
  s_add_u32 m0, s64, 33792
  s_nop 0
  buffer_load_dwordx4 v13, s[16:19], s60 offen lds
  s_add_u32 m0, s64, 34816
  s_nop 0
  buffer_load_dwordx4 v14, s[16:19], s60 offen lds
  s_add_u32 m0, s64, 35840
  s_nop 0
  buffer_load_dwordx4 v15, s[16:19], s60 offen lds
  s_waitcnt vmcnt(8)
  s_add_u32 m0, s64, 49152
  s_nop 0
  buffer_load_dwordx4 v20, s[16:19], s61 offen lds
  s_add_u32 m0, s64, 50176
  s_nop 0
  buffer_load_dwordx4 v21, s[16:19], s61 offen lds
  s_add_u32 m0, s64, 51200
  s_nop 0
  buffer_load_dwordx4 v22, s[16:19], s61 offen lds
  s_add_u32 m0, s64, 52224
  s_nop 0
  buffer_load_dwordx4 v23, s[16:19], s61 offen lds
  s_barrier
  s_waitcnt vmcnt(16)
  s_barrier
  s_add_u32 s62, s65, 10
  s_sub_u32 s59, s62, 7
  s_cselect_b32 s62, s62, s59
  s_cselect_b32 s60, 0, 28672
  s_add_u32 s62, s62, s55
  s_sub_u32 s59, s62, 7
  s_cselect_b32 s62, s62, s59
  s_mul_i32 s62, s62, 114688
  s_add_u32 s60, s60, s62
  s_add_u32 s60, s60, s58
  s_add_u32 s61, s60, 802816
  s_add_u32 m0, s64, 65536
  s_nop 0
  buffer_load_dwordx4 v12, s[16:19], s60 offen lds
  s_add_u32 m0, s64, 66560
  s_nop 0
  buffer_load_dwordx4 v13, s[16:19], s60 offen lds
  s_add_u32 m0, s64, 67584
  s_nop 0
  buffer_load_dwordx4 v14, s[16:19], s60 offen lds
  s_add_u32 m0, s64, 68608
  s_nop 0
  buffer_load_dwordx4 v15, s[16:19], s60 offen lds
  s_add_u32 m0, s64, 81920
  s_nop 0
  buffer_load_dwordx4 v20, s[16:19], s61 offen lds
  s_add_u32 m0, s64, 82944
  s_nop 0
  buffer_load_dwordx4 v21, s[16:19], s61 offen lds
  s_add_u32 m0, s64, 83968
  s_nop 0
  buffer_load_dwordx4 v22, s[16:19], s61 offen lds
  s_add_u32 m0, s64, 84992
  s_nop 0
  buffer_load_dwordx4 v23, s[16:19], s61 offen lds
  s_waitcnt vmcnt(8)
  s_barrier
  s_add_u32 s62, s65, 12
  s_sub_u32 s59, s62, 7
  s_cselect_b32 s62, s62, s59
  s_cselect_b32 s60, 0, 28672
  s_add_u32 s62, s62, s55
  s_sub_u32 s59, s62, 7
  s_cselect_b32 s62, s62, s59
  s_mul_i32 s62, s62, 114688
  s_add_u32 s60, s60, s62
  s_add_u32 s60, s60, s58
  s_add_u32 s61, s60, 802816
  s_add_u32 m0, s64, 98304
  s_nop 0
  buffer_load_dwordx4 v12, s[16:19], s60 offen lds
  s_add_u32 m0, s64, 99328
  s_nop 0
  buffer_load_dwordx4 v13, s[16:19], s60 offen lds
  s_add_u32 m0, s64, 100352
  s_nop 0
  buffer_load_dwordx4 v14, s[16:19], s60 offen lds
  s_add_u32 m0, s64, 101376
  s_nop 0
  buffer_load_dwordx4 v15, s[16:19], s60 offen lds
  s_add_u32 m0, s64, 114688
  s_nop 0
  buffer_load_dwordx4 v20, s[16:19], s61 offen lds
  s_add_u32 m0, s64, 115712
  s_nop 0
  buffer_load_dwordx4 v21, s[16:19], s61 offen lds
  s_add_u32 m0, s64, 116736
  s_nop 0
  buffer_load_dwordx4 v22, s[16:19], s61 offen lds
  s_add_u32 m0, s64, 117760
  s_nop 0
  buffer_load_dwordx4 v23, s[16:19], s61 offen lds
  s_waitcnt vmcnt(0)
  s_barrier
L_end:
  s_endpgm
L_compute:
  s_lshl_b32 s54, s48, 2
  s_add_u32 s54, s54, s50
  v_lshlrev_b32 v14, 4, v1
  s_cmp_lg_u32 s3, 3
  s_cbranch_scc1 L_nocpf
  s_getpc_b64 s[32:33]
L_pc:
  s_cmp_ge_u32 s49, (L_codeend - standalone__dense_activation_relu__prompt_kernel + 1023) / 1024
  s_cbranch_scc1 L_nocpf
  s_lshl_b32 s59, s49, 10
  s_sub_u32 s59, s59, L_pc - standalone__dense_activation_relu__prompt_kernel
  s_ashr_i32 s62, s59, 31
  s_add_u32 s32, s32, s59
  s_addc_u32 s33, s33, s62
  v_mov_b32 v17, s33
  v_add_co_u32 v16, vcc, s32, v14
  s_nop 1
  v_addc_co_u32 v17, vcc, 0, v17, vcc
  global_load_dwordx4 v[80:83], v[16:17], off
L_nocpf:
  v_lshrrev_b32 v2, 5, v1
  v_and_b32 v3, 31, v1
  s_and_b32 s57, s3, 1
  s_lshr_b32 s58, s3, 1
  s_waitcnt lgkmcnt(0)
  s_mov_b32 s28, s46
  s_mov_b32 s29, s47
  s_mov_b32 s30, 7397376
  s_mov_b32 s31, 0x20000
  s_lshl_b32 s59, s54, 8
  s_add_u32 s59, s59, 7340032
  s_add_u32 s74, s46, s59
  s_addc_u32 s75, s47, 0
  s_or_b32 s59, s51, s3
  s_cmp_lg_u32 s59, 0
  s_cbranch_scc1 L_nolead0
  s_mov_b32 s76, 0
  s_mov_b32 s77, 0
  s_atomic_swap s76, s[74:75], 0 glc
  s_atomic_swap s77, s[74:75], 128 glc
  s_lshl_b32 s59, s54, 3
  s_add_u32 s80, s44, s59
  s_addc_u32 s81, s45, 0
  s_mov_b32 s82, -1
  s_waitcnt lgkmcnt(0)
  s_atomic_swap s82, s[80:81], 0
L_nolead0:
  s_mov_b32 s24, s44
  s_mov_b32 s25, s45
  s_mov_b32 s26, 256
  s_mov_b32 s27, 0x20000
  s_mov_b32 s20, s42
  s_mov_b32 s21, s43
  s_mov_b32 s22, 1835008
  s_mov_b32 s23, 0x20000
  v_bfe_u32 v4, v1, 2, 2
  v_lshlrev_b32 v4, 6, v4
  v_bfe_u32 v5, v1, 4, 1
  v_lshl_add_u32 v6, v5, 5, v4
  v_and_b32 v7, 3, v1
  v_lshl_add_u32 v6, v7, 3, v6
  s_lshl_b32 s59, s57, 9
  s_add_u32 s59, s59, 16384
  v_lshl_add_u32 v6, v2, 11, v6
  v_add_u32 v6, s59, v6
  v_add_u32 v7, 0x10000, v6
  v_add_u32 v8, 0x20000, v6
  v_lshl_add_u32 v4, v5, 4, v4
  v_and_b32 v5, 1, v1
  v_lshl_add_u32 v4, v5, 5, v4
  v_bfe_u32 v5, v1, 1, 1
  v_lshl_add_u32 v4, v5, 3, v4
  s_lshl_b32 s59, s57, 14
  v_lshl_add_u32 v4, v2, 9, v4
  v_add_u32 v252, s59, v4
  v_add_u32 v253, 0x10000, v252
  v_add_u32 v254, 0x20000, v252
  v_bfe_u32 v5, v1, 1, 3
  v_xor_b32 v5, v5, v2
  v_lshlrev_b32 v5, 4, v5
  v_lshl_add_u32 v240, v3, 7, v5
  s_lshl_b32 s59, s58, 13
  v_add_u32 v240, s59, v240
  v_xor_b32 v243, 32, v240
  v_xor_b32 v246, 64, v240
  v_xor_b32 v249, 96, v240
  v_add_u32 v241, 0x10000, v240
  v_add_u32 v242, 0x20000, v240
  v_add_u32 v244, 0x10000, v243
  v_add_u32 v245, 0x20000, v243
  v_add_u32 v247, 0x10000, v246
  v_add_u32 v248, 0x20000, v246
  v_add_u32 v250, 0x10000, v249
  v_add_u32 v251, 0x20000, v249
  v_and_b32 v4, 7, v1
  v_lshlrev_b32 v5, 2, v2
  v_xor_b32 v5, v5, v4
  v_lshlrev_b32 v5, 4, v5
  v_lshl_add_u32 v10, v3, 8, v5
  s_lshl_b32 s59, s57, 14
  s_lshl_b32 s62, s58, 13
  s_add_u32 s59, s59, s62
  s_lshl_b32 s62, s57, 7
  s_add_u32 s59, s59, s62
  s_add_u32 s59, s59, 0x20000
  v_add_u32 v10, s59, v10
  v_lshrrev_b32 v5, 3, v1
  v_lshlrev_b32 v11, 1, v4
  v_xor_b32 v11, v11, v5
  v_lshlrev_b32 v11, 4, v11
  v_lshl_add_u32 v11, v5, 8, v11
  s_lshl_b32 s59, s3, 12
  s_add_u32 s59, s59, 0x20000
  v_add_u32 v11, s59, v11
  v_mul_u32_u24 v12, 896, v5
  v_lshl_add_u32 v12, v4, 4, v12
  s_lshl_b32 s56, s54, 6
  s_lshl_b32 s62, s3, 4
  s_add_u32 s56, s56, s62
  s_mul_i32 s56, s56, 896
  s_lshl_b32 s62, s51, 7
  s_add_u32 s56, s56, s62
  s_lshl_b32 s60, s52, 2
  s_lshl_b32 s59, s58, 1
  s_add_u32 s60, s60, s59
  s_mul_i32 s60, s60, 112
  s_lshl_b32 s59, s53, 3
  s_add_u32 s60, s60, s59
  s_lshl_b32 s59, s57, 2
  s_add_u32 s60, s60, s59
  s_lshl_b32 s60, s60, 10
  s_add_u32 s61, s60, 114688
  s_lshl_b32 s59, s52, 1
  s_add_u32 s59, s59, s58
  s_lshl_b32 s64, s59, 3
  s_lshl_b32 s59, s59, 1
  s_cmp_ge_u32 s53, 7
  s_addc_u32 s59, s59, 0
  s_lshl_b32 s59, s59, 7
  s_add_u32 s59, s59, 7340032
  s_add_u32 s72, s46, s59
  s_addc_u32 s73, s47, 0
  v_cmp_eq_u32 vcc, 0, v1
  s_lshl_b32 s65, s54, 3
  v_mov_b32 v4, s65
  v_mov_b32 v5, s64
  v_cndmask_b32 v4, v4, v5, vcc
  s_lshl_b32 s59, s57, 7
  s_add_u32 s74, s74, s59
  s_addc_u32 s75, s75, 0
  s_and_b32 s59, s52, 1
  s_mul_i32 s59, s59, 4
  s_lshr_b32 s62, s52, 1
  s_add_u32 s59, s59, s62
  s_add_u32 s78, s51, 14
  s_sub_u32 s78, s78, s59
  s_sub_u32 s59, s78, 7
  s_cselect_b32 s78, s78, s59
  s_sub_u32 s59, s78, 7
  s_cselect_b32 s78, s78, s59
  s_lshl_b32 s78, s78, 1
  s_lshl_b32 s78, 1, s78
  s_lshl_b32 s79, s78, 14
  s_lshr_b32 s55, s50, 1
  s_mul_i32 s55, s55, 4
  s_add_u32 s55, s55, s48
  s_sub_u32 s59, s55, 7
  s_cselect_b32 s55, s55, s59
  s_lshl_b32 s62, s54, 1
  s_add_u32 s62, s62, s58
  s_mul_i32 s62, s62, 112
  s_mul_i32 s59, s57, 56
  s_add_u32 s62, s62, s59
  s_lshl_b32 s62, s62, 10
  s_mov_b32 s63, s55
  s_lshl_b32 s59, s63, 13
  s_add_u32 s4, s62, s59
  s_add_u32 s63, s63, 1
  s_cmp_eq_u32 s63, 7
  s_cselect_b32 s63, 0, s63
  s_lshl_b32 s59, s63, 13
  s_add_u32 s5, s62, s59
  s_add_u32 s63, s63, 1
  s_cmp_eq_u32 s63, 7
  s_cselect_b32 s63, 0, s63
  s_lshl_b32 s59, s63, 13
  s_add_u32 s6, s62, s59
  s_add_u32 s63, s63, 1
  s_cmp_eq_u32 s63, 7
  s_cselect_b32 s63, 0, s63
  s_lshl_b32 s59, s63, 13
  s_add_u32 s7, s62, s59
  s_add_u32 s63, s63, 1
  s_cmp_eq_u32 s63, 7
  s_cselect_b32 s63, 0, s63
  s_lshl_b32 s59, s63, 13
  s_add_u32 s32, s62, s59
  s_add_u32 s63, s63, 1
  s_cmp_eq_u32 s63, 7
  s_cselect_b32 s63, 0, s63
  s_lshl_b32 s59, s63, 13
  s_add_u32 s33, s62, s59
  s_add_u32 s63, s63, 1
  s_cmp_eq_u32 s63, 7
  s_cselect_b32 s63, 0, s63
  s_lshl_b32 s59, s63, 13
  s_add_u32 s34, s62, s59
  s_add_u32 s59, s51, 0
  s_and_b32 s62, s59, 1
  s_bfe_u32 s59, s59, 0x10001
  s_lshl_b32 s59, s59, 2
  s_add_u32 s59, s59, s62
  s_lshl_b32 s59, s59, 10
  v_add_u32 v0, s59, v14
  s_add_u32 s59, s51, 1
  s_and_b32 s62, s59, 1
  s_bfe_u32 s59, s59, 0x10001
  s_lshl_b32 s59, s59, 2
  s_add_u32 s59, s59, s62
  s_lshl_b32 s59, s59, 10
  v_add_u32 v9, s59, v14
  s_add_u32 s59, s51, 2
  s_and_b32 s62, s59, 1
  s_bfe_u32 s59, s59, 0x10001
  s_lshl_b32 s59, s59, 2
  s_add_u32 s59, s59, s62
  s_lshl_b32 s59, s59, 10
  v_add_u32 v13, s59, v14
  s_add_u32 s59, s51, 3
  s_and_b32 s62, s59, 1
  s_bfe_u32 s59, s59, 0x10001
  s_lshl_b32 s59, s59, 2
  s_add_u32 s59, s59, s62
  s_lshl_b32 s59, s59, 10
  v_add_u32 v15, s59, v14
  s_waitcnt vmcnt(0) lgkmcnt(0)
  s_barrier
  ds_read_b64_tr_b16 v[80:81], v6 offset:0
  ds_read_b64_tr_b16 v[82:83], v6 offset:1024
  ds_read_b128 v[84:87], v240 offset:0
  s_waitcnt lgkmcnt(0)
  v_mfma_f32_32x32x16_bf16 v[16:31], v[80:83], v[84:87], 0
  ds_read_b128 v[88:91], v240 offset:4096
  ds_read_b64_tr_b16 v[92:93], v6 offset:256
  ds_read_b64_tr_b16 v[94:95], v6 offset:1280
  s_waitcnt lgkmcnt(2)
  v_mfma_f32_32x32x16_bf16 v[32:47], v[80:83], v[88:91], 0
  ds_read_b64_tr_b16 v[96:97], v6 offset:4096
  ds_read_b64_tr_b16 v[98:99], v6 offset:5120
  ds_read_b128 v[100:103], v243 offset:0
  s_waitcnt lgkmcnt(3)
  v_mfma_f32_32x32x16_bf16 v[64:79], v[92:95], v[88:91], 0
  ds_read_b128 v[104:107], v243 offset:4096
  ds_read_b64_tr_b16 v[108:109], v6 offset:4352
  ds_read_b64_tr_b16 v[110:111], v6 offset:5376
  v_mfma_f32_32x32x16_bf16 v[48:63], v[92:95], v[84:87], 0
  ds_read_b64_tr_b16 v[208:209], v6 offset:8192
  ds_read_b64_tr_b16 v[210:211], v6 offset:9216
  ds_read_b128 v[212:215], v246 offset:0
  s_waitcnt lgkmcnt(6)
  v_mfma_f32_32x32x16_bf16 v[16:31], v[96:99], v[100:103], v[16:31]
  ds_read_b128 v[216:219], v246 offset:4096
  ds_read_b64_tr_b16 v[220:221], v6 offset:8448
  ds_read_b64_tr_b16 v[222:223], v6 offset:9472
  s_waitcnt lgkmcnt(8)
  v_mfma_f32_32x32x16_bf16 v[32:47], v[96:99], v[104:107], v[32:47]
  ds_read_b64_tr_b16 v[224:225], v6 offset:12288
  ds_read_b64_tr_b16 v[226:227], v6 offset:13312
  ds_read_b128 v[228:231], v249 offset:0
  s_waitcnt lgkmcnt(9)
  v_mfma_f32_32x32x16_bf16 v[64:79], v[108:111], v[104:107], v[64:79]
  ds_read_b128 v[232:235], v249 offset:4096
  ds_read_b64_tr_b16 v[236:237], v6 offset:12544
  ds_read_b64_tr_b16 v[238:239], v6 offset:13568
  v_mfma_f32_32x32x16_bf16 v[48:63], v[108:111], v[100:103], v[48:63]
  s_waitcnt lgkmcnt(9)
  v_mfma_f32_32x32x16_bf16 v[16:31], v[208:211], v[212:215], v[16:31]
  s_waitcnt lgkmcnt(8)
  v_mfma_f32_32x32x16_bf16 v[32:47], v[208:211], v[216:219], v[32:47]
  s_waitcnt lgkmcnt(6)
  v_mfma_f32_32x32x16_bf16 v[64:79], v[220:223], v[216:219], v[64:79]
  v_mfma_f32_32x32x16_bf16 v[48:63], v[220:223], v[212:215], v[48:63]
  s_waitcnt lgkmcnt(3)
  v_mfma_f32_32x32x16_bf16 v[16:31], v[224:227], v[228:231], v[16:31]
  s_waitcnt lgkmcnt(2)
  v_mfma_f32_32x32x16_bf16 v[32:47], v[224:227], v[232:235], v[32:47]
  s_barrier
  ds_read_b64_tr_b16 v[80:81], v6 offset:32768
  ds_read_b64_tr_b16 v[82:83], v6 offset:33792
  ds_read_b128 v[88:91], v240 offset:32768
  s_waitcnt lgkmcnt(3)
  v_mfma_f32_32x32x16_bf16 v[64:79], v[236:239], v[232:235], v[64:79]
  ds_read_b128 v[92:95], v240 offset:36864
  ds_read_b64_tr_b16 v[84:85], v6 offset:33024
  ds_read_b64_tr_b16 v[86:87], v6 offset:34048
  v_mfma_f32_32x32x16_bf16 v[48:63], v[236:239], v[228:231], v[48:63]
  ds_read_b64_tr_b16 v[96:97], v6 offset:36864
  ds_read_b64_tr_b16 v[98:99], v6 offset:37888
  ds_read_b128 v[104:107], v243 offset:32768
  s_waitcnt lgkmcnt(6)
  v_mfma_f32_32x32x16_bf16 v[16:31], v[80:83], v[88:91], v[16:31]
  ds_read_b128 v[108:111], v243 offset:36864
  ds_read_b64_tr_b16 v[100:101], v6 offset:37120
  ds_read_b64_tr_b16 v[102:103], v6 offset:38144
  s_waitcnt lgkmcnt(8)
  v_mfma_f32_32x32x16_bf16 v[32:47], v[80:83], v[92:95], v[32:47]
  ds_read_b64_tr_b16 v[208:209], v6 offset:40960
  ds_read_b64_tr_b16 v[210:211], v6 offset:41984
  ds_read_b128 v[216:219], v246 offset:32768
  s_waitcnt lgkmcnt(9)
  v_mfma_f32_32x32x16_bf16 v[64:79], v[84:87], v[92:95], v[64:79]
  ds_read_b128 v[220:223], v246 offset:36864
  ds_read_b64_tr_b16 v[212:213], v6 offset:41216
  ds_read_b64_tr_b16 v[214:215], v6 offset:42240
  v_mfma_f32_32x32x16_bf16 v[48:63], v[84:87], v[88:91], v[48:63]
  s_waitcnt lgkmcnt(9)
  v_mfma_f32_32x32x16_bf16 v[16:31], v[96:99], v[104:107], v[16:31]
  ds_read_b64_tr_b16 v[224:225], v6 offset:45056
  ds_read_b64_tr_b16 v[226:227], v6 offset:46080
  ds_read_b128 v[232:235], v249 offset:32768
  s_waitcnt lgkmcnt(11)
  v_mfma_f32_32x32x16_bf16 v[32:47], v[96:99], v[108:111], v[32:47]
  ds_read_b128 v[236:239], v249 offset:36864
  s_waitcnt lgkmcnt(10)
  v_mfma_f32_32x32x16_bf16 v[64:79], v[100:103], v[108:111], v[64:79]
  ds_read_b64_tr_b16 v[228:229], v6 offset:45312
  ds_read_b64_tr_b16 v[230:231], v6 offset:46336
  v_mfma_f32_32x32x16_bf16 v[48:63], v[100:103], v[104:107], v[48:63]
  s_waitcnt lgkmcnt(9)
  v_mfma_f32_32x32x16_bf16 v[16:31], v[208:211], v[216:219], v[16:31]
  s_waitcnt lgkmcnt(8)
  v_mfma_f32_32x32x16_bf16 v[32:47], v[208:211], v[220:223], v[32:47]
  s_waitcnt lgkmcnt(6)
  v_mfma_f32_32x32x16_bf16 v[64:79], v[212:215], v[220:223], v[64:79]
  v_mfma_f32_32x32x16_bf16 v[48:63], v[212:215], v[216:219], v[48:63]
  s_waitcnt lgkmcnt(3)
  v_mfma_f32_32x32x16_bf16 v[16:31], v[224:227], v[232:235], v[16:31]
  s_waitcnt lgkmcnt(2)
  v_mfma_f32_32x32x16_bf16 v[32:47], v[224:227], v[236:239], v[32:47]
  s_barrier
  ds_read_b64_tr_b16 v[80:81], v7 offset:0
  ds_read_b64_tr_b16 v[82:83], v7 offset:1024
  ds_read_b128 v[92:95], v241 offset:0
  s_waitcnt lgkmcnt(3)
  v_mfma_f32_32x32x16_bf16 v[64:79], v[228:231], v[236:239], v[64:79]
  ds_read_b128 v[84:87], v241 offset:4096
  ds_read_b64_tr_b16 v[88:89], v7 offset:256
  ds_read_b64_tr_b16 v[90:91], v7 offset:1280
  v_mfma_f32_32x32x16_bf16 v[48:63], v[228:231], v[232:235], v[48:63]
  ds_read_b64_tr_b16 v[96:97], v7 offset:4096
  ds_read_b64_tr_b16 v[98:99], v7 offset:5120
  ds_read_b128 v[108:111], v244 offset:0
  s_waitcnt lgkmcnt(6)
  v_mfma_f32_32x32x16_bf16 v[16:31], v[80:83], v[92:95], v[16:31]
  ds_read_b128 v[100:103], v244 offset:4096
  ds_read_b64_tr_b16 v[104:105], v7 offset:4352
  ds_read_b64_tr_b16 v[106:107], v7 offset:5376
  s_waitcnt lgkmcnt(8)
  v_mfma_f32_32x32x16_bf16 v[32:47], v[80:83], v[84:87], v[32:47]
  ds_read_b64_tr_b16 v[208:209], v7 offset:8192
  ds_read_b64_tr_b16 v[210:211], v7 offset:9216
  ds_read_b128 v[220:223], v247 offset:0
  s_waitcnt lgkmcnt(9)
  v_mfma_f32_32x32x16_bf16 v[64:79], v[88:91], v[84:87], v[64:79]
  ds_read_b128 v[212:215], v247 offset:4096
  ds_read_b64_tr_b16 v[216:217], v7 offset:8448
  ds_read_b64_tr_b16 v[218:219], v7 offset:9472
  v_mfma_f32_32x32x16_bf16 v[48:63], v[88:91], v[92:95], v[48:63]
  s_waitcnt lgkmcnt(9)
  v_mfma_f32_32x32x16_bf16 v[16:31], v[96:99], v[108:111], v[16:31]
  ds_read_b64_tr_b16 v[224:225], v7 offset:12288
  ds_read_b64_tr_b16 v[226:227], v7 offset:13312
  ds_read_b128 v[236:239], v250 offset:0
  s_waitcnt lgkmcnt(11)
  v_mfma_f32_32x32x16_bf16 v[32:47], v[96:99], v[100:103], v[32:47]
  ds_read_b128 v[228:231], v250 offset:4096
  s_waitcnt lgkmcnt(10)
  v_mfma_f32_32x32x16_bf16 v[64:79], v[104:107], v[100:103], v[64:79]
  ds_read_b64_tr_b16 v[232:233], v7 offset:12544
  ds_read_b64_tr_b16 v[234:235], v7 offset:13568
  v_mfma_f32_32x32x16_bf16 v[48:63], v[104:107], v[108:111], v[48:63]
  s_waitcnt lgkmcnt(9)
  v_mfma_f32_32x32x16_bf16 v[16:31], v[208:211], v[220:223], v[16:31]
  s_waitcnt lgkmcnt(8)
  v_mfma_f32_32x32x16_bf16 v[32:47], v[208:211], v[212:215], v[32:47]
  s_waitcnt lgkmcnt(6)
  v_mfma_f32_32x32x16_bf16 v[64:79], v[216:219], v[212:215], v[64:79]
  v_mfma_f32_32x32x16_bf16 v[48:63], v[216:219], v[220:223], v[48:63]
  s_waitcnt lgkmcnt(3)
  v_mfma_f32_32x32x16_bf16 v[16:31], v[224:227], v[236:239], v[16:31]
  s_waitcnt lgkmcnt(2)
  v_mfma_f32_32x32x16_bf16 v[32:47], v[224:227], v[228:231], v[32:47]
  s_barrier
  ds_read_b64_tr_b16 v[80:81], v7 offset:32768
  ds_read_b64_tr_b16 v[82:83], v7 offset:33792
  ds_read_b128 v[84:87], v241 offset:32768
  s_waitcnt lgkmcnt(3)
  v_mfma_f32_32x32x16_bf16 v[64:79], v[232:235], v[228:231], v[64:79]
  ds_read_b128 v[88:91], v241 offset:36864
  ds_read_b64_tr_b16 v[92:93], v7 offset:33024
  ds_read_b64_tr_b16 v[94:95], v7 offset:34048
  v_mfma_f32_32x32x16_bf16 v[48:63], v[232:235], v[236:239], v[48:63]
  ds_read_b64_tr_b16 v[96:97], v7 offset:36864
  ds_read_b64_tr_b16 v[98:99], v7 offset:37888
  ds_read_b128 v[100:103], v244 offset:32768
  s_waitcnt lgkmcnt(6)
  v_mfma_f32_32x32x16_bf16 v[16:31], v[80:83], v[84:87], v[16:31]
  ds_read_b128 v[104:107], v244 offset:36864
  ds_read_b64_tr_b16 v[108:109], v7 offset:37120
  ds_read_b64_tr_b16 v[110:111], v7 offset:38144
  s_waitcnt lgkmcnt(8)
  v_mfma_f32_32x32x16_bf16 v[32:47], v[80:83], v[88:91], v[32:47]
  ds_read_b64_tr_b16 v[208:209], v7 offset:40960
  ds_read_b64_tr_b16 v[210:211], v7 offset:41984
  ds_read_b128 v[212:215], v247 offset:32768
  s_waitcnt lgkmcnt(9)
  v_mfma_f32_32x32x16_bf16 v[64:79], v[92:95], v[88:91], v[64:79]
  ds_read_b128 v[216:219], v247 offset:36864
  ds_read_b64_tr_b16 v[220:221], v7 offset:41216
  ds_read_b64_tr_b16 v[222:223], v7 offset:42240
  v_mfma_f32_32x32x16_bf16 v[48:63], v[92:95], v[84:87], v[48:63]
  s_waitcnt lgkmcnt(9)
  v_mfma_f32_32x32x16_bf16 v[16:31], v[96:99], v[100:103], v[16:31]
  ds_read_b64_tr_b16 v[224:225], v7 offset:45056
  ds_read_b64_tr_b16 v[226:227], v7 offset:46080
  ds_read_b128 v[228:231], v250 offset:32768
  s_waitcnt lgkmcnt(11)
  v_mfma_f32_32x32x16_bf16 v[32:47], v[96:99], v[104:107], v[32:47]
  ds_read_b128 v[232:235], v250 offset:36864
  s_waitcnt lgkmcnt(10)
  v_mfma_f32_32x32x16_bf16 v[64:79], v[108:111], v[104:107], v[64:79]
  ds_read_b64_tr_b16 v[236:237], v7 offset:45312
  ds_read_b64_tr_b16 v[238:239], v7 offset:46336
  v_mfma_f32_32x32x16_bf16 v[48:63], v[108:111], v[100:103], v[48:63]
  s_waitcnt lgkmcnt(9)
  v_mfma_f32_32x32x16_bf16 v[16:31], v[208:211], v[212:215], v[16:31]
  s_waitcnt lgkmcnt(8)
  v_mfma_f32_32x32x16_bf16 v[32:47], v[208:211], v[216:219], v[32:47]
  s_waitcnt lgkmcnt(6)
  v_mfma_f32_32x32x16_bf16 v[64:79], v[220:223], v[216:219], v[64:79]
  v_mfma_f32_32x32x16_bf16 v[48:63], v[220:223], v[212:215], v[48:63]
  s_waitcnt lgkmcnt(3)
  v_mfma_f32_32x32x16_bf16 v[16:31], v[224:227], v[228:231], v[16:31]
  s_waitcnt lgkmcnt(2)
  v_mfma_f32_32x32x16_bf16 v[32:47], v[224:227], v[232:235], v[32:47]
  s_barrier
  ds_read_b64_tr_b16 v[80:81], v8 offset:0
  ds_read_b64_tr_b16 v[82:83], v8 offset:1024
  ds_read_b128 v[112:115], v242 offset:0
  s_waitcnt lgkmcnt(3)
  v_mfma_f32_32x32x16_bf16 v[64:79], v[236:239], v[232:235], v[64:79]
  ds_read_b128 v[116:119], v242 offset:4096
  ds_read_b64_tr_b16 v[88:89], v8 offset:4096
  ds_read_b64_tr_b16 v[90:91], v8 offset:5120
  v_mfma_f32_32x32x16_bf16 v[48:63], v[236:239], v[228:231], v[48:63]
  ds_read_b128 v[120:123], v245 offset:0
  ds_read_b128 v[124:127], v245 offset:4096
  ds_read_b64_tr_b16 v[92:93], v8 offset:8192
  ds_read_b64_tr_b16 v[94:95], v8 offset:9216
  s_waitcnt lgkmcnt(7)
  v_mfma_f32_32x32x16_bf16 v[16:31], v[80:83], v[112:115], v[16:31]
  ds_read_b128 v[128:131], v248 offset:0
  ds_read_b128 v[132:135], v248 offset:4096
  ds_read_b64_tr_b16 v[84:85], v8 offset:12288
  ds_read_b64_tr_b16 v[86:87], v8 offset:13312
  s_waitcnt lgkmcnt(10)
  v_mfma_f32_32x32x16_bf16 v[32:47], v[80:83], v[116:119], v[32:47]
  ds_read_b128 v[136:139], v251 offset:0
  ds_read_b128 v[140:143], v251 offset:4096
  s_waitcnt lgkmcnt(9)
  v_mfma_f32_32x32x16_bf16 v[16:31], v[88:91], v[120:123], v[16:31]
  s_waitcnt lgkmcnt(8)
  v_mfma_f32_32x32x16_bf16 v[32:47], v[88:91], v[124:127], v[32:47]
  s_waitcnt lgkmcnt(5)
  v_mfma_f32_32x32x16_bf16 v[16:31], v[92:95], v[128:131], v[16:31]
  s_waitcnt lgkmcnt(4)
  v_mfma_f32_32x32x16_bf16 v[32:47], v[92:95], v[132:135], v[32:47]
  s_barrier
  ds_read_b64_tr_b16 v[96:97], v6 offset:0
  ds_read_b64_tr_b16 v[98:99], v6 offset:1024
  ds_read_b128 v[144:147], v240 offset:0
  s_waitcnt lgkmcnt(4)
  v_mfma_f32_32x32x16_bf16 v[16:31], v[84:87], v[136:139], v[16:31]
  ds_read_b128 v[148:151], v240 offset:4096
  ds_read_b64_tr_b16 v[104:105], v6 offset:4096
  ds_read_b64_tr_b16 v[106:107], v6 offset:5120
  s_waitcnt lgkmcnt(6)
  v_mfma_f32_32x32x16_bf16 v[32:47], v[84:87], v[140:143], v[32:47]
  ds_read_b128 v[152:155], v243 offset:0
  ds_read_b128 v[156:159], v243 offset:4096
  ds_read_b64_tr_b16 v[108:109], v6 offset:8192
  ds_read_b64_tr_b16 v[110:111], v6 offset:9216
  s_waitcnt lgkmcnt(7)
  v_mfma_f32_32x32x16_bf16 v[16:31], v[96:99], v[144:147], v[16:31]
  ds_read_b128 v[160:163], v246 offset:0
  ds_read_b128 v[164:167], v246 offset:4096
  ds_read_b64_tr_b16 v[100:101], v6 offset:12288
  ds_read_b64_tr_b16 v[102:103], v6 offset:13312
  s_waitcnt lgkmcnt(10)
  v_mfma_f32_32x32x16_bf16 v[32:47], v[96:99], v[148:151], v[32:47]
  ds_read_b128 v[168:171], v249 offset:0
  ds_read_b128 v[172:175], v249 offset:4096
  s_waitcnt lgkmcnt(9)
  v_mfma_f32_32x32x16_bf16 v[16:31], v[104:107], v[152:155], v[16:31]
  s_waitcnt lgkmcnt(8)
  v_mfma_f32_32x32x16_bf16 v[32:47], v[104:107], v[156:159], v[32:47]
  s_waitcnt lgkmcnt(5)
  v_mfma_f32_32x32x16_bf16 v[16:31], v[108:111], v[160:163], v[16:31]
  s_waitcnt lgkmcnt(4)
  v_mfma_f32_32x32x16_bf16 v[32:47], v[108:111], v[164:167], v[32:47]
  s_barrier
  ds_read_b64_tr_b16 v[208:209], v6 offset:32768
  ds_read_b64_tr_b16 v[210:211], v6 offset:33792
  ds_read_b128 v[176:179], v240 offset:32768
  s_waitcnt lgkmcnt(4)
  v_mfma_f32_32x32x16_bf16 v[16:31], v[100:103], v[168:171], v[16:31]
  ds_read_b128 v[180:183], v240 offset:36864
  ds_read_b64_tr_b16 v[216:217], v6 offset:36864
  ds_read_b64_tr_b16 v[218:219], v6 offset:37888
  s_waitcnt lgkmcnt(6)
  v_mfma_f32_32x32x16_bf16 v[32:47], v[100:103], v[172:175], v[32:47]
  ds_read_b128 v[184:187], v243 offset:32768
  ds_read_b128 v[188:191], v243 offset:36864
  ds_read_b64_tr_b16 v[220:221], v6 offset:40960
  ds_read_b64_tr_b16 v[222:223], v6 offset:41984
  s_waitcnt lgkmcnt(7)
  v_mfma_f32_32x32x16_bf16 v[16:31], v[208:211], v[176:179], v[16:31]
  ds_read_b128 v[192:195], v246 offset:32768
  ds_read_b128 v[196:199], v246 offset:36864
  ds_read_b64_tr_b16 v[212:213], v6 offset:45056
  ds_read_b64_tr_b16 v[214:215], v6 offset:46080
  s_waitcnt lgkmcnt(10)
  v_mfma_f32_32x32x16_bf16 v[32:47], v[208:211], v[180:183], v[32:47]
  ds_read_b128 v[200:203], v249 offset:32768
  ds_read_b128 v[204:207], v249 offset:36864
  ds_read_b64_tr_b16 v[224:225], v8 offset:256
  ds_read_b64_tr_b16 v[226:227], v8 offset:1280
  s_waitcnt lgkmcnt(11)
  v_mfma_f32_32x32x16_bf16 v[16:31], v[216:219], v[184:187], v[16:31]
  ds_read_b64_tr_b16 v[232:233], v8 offset:4352
  ds_read_b64_tr_b16 v[234:235], v8 offset:5376
  s_waitcnt lgkmcnt(12)
  v_mfma_f32_32x32x16_bf16 v[32:47], v[216:219], v[188:191], v[32:47]
  s_waitcnt lgkmcnt(9)
  v_mfma_f32_32x32x16_bf16 v[16:31], v[220:223], v[192:195], v[16:31]
  ds_read_b64_tr_b16 v[236:237], v8 offset:8448
  ds_read_b64_tr_b16 v[238:239], v8 offset:9472
  s_waitcnt lgkmcnt(10)
  v_mfma_f32_32x32x16_bf16 v[32:47], v[220:223], v[196:199], v[32:47]
  s_waitcnt lgkmcnt(7)
  v_mfma_f32_32x32x16_bf16 v[16:31], v[212:215], v[200:203], v[16:31]
  ds_read_b64_tr_b16 v[228:229], v8 offset:12544
  ds_read_b64_tr_b16 v[230:231], v8 offset:13568
  s_waitcnt lgkmcnt(8)
  v_mfma_f32_32x32x16_bf16 v[32:47], v[212:215], v[204:207], v[32:47]
  s_waitcnt lgkmcnt(6)
  v_mfma_f32_32x32x16_bf16 v[48:63], v[224:227], v[112:115], v[48:63]
  ds_read_b64_tr_b16 v[80:81], v6 offset:256
  ds_read_b64_tr_b16 v[82:83], v6 offset:1280
  v_mfma_f32_32x32x16_bf16 v[64:79], v[224:227], v[116:119], v[64:79]
  s_waitcnt lgkmcnt(6)
  v_mfma_f32_32x32x16_bf16 v[48:63], v[232:235], v[120:123], v[48:63]
  ds_read_b64_tr_b16 v[88:89], v6 offset:4352
  ds_read_b64_tr_b16 v[90:91], v6 offset:5376
  s_nop 0
  s_nop 0
  s_nop 0
  s_nop 0
  s_nop 0
  buffer_load_dword v5, v4, s[24:27], 0 offen sc1
  v_cvt_pk_bf16_f32 v16, v16, v17
  v_cvt_pk_bf16_f32 v17, v18, v19
  v_cvt_pk_bf16_f32 v18, v20, v21
  v_cvt_pk_bf16_f32 v19, v22, v23
  v_mfma_f32_32x32x16_bf16 v[64:79], v[232:235], v[124:127], v[64:79]
  v_cvt_pk_bf16_f32 v20, v24, v25
  v_cvt_pk_bf16_f32 v21, v26, v27
  v_cvt_pk_bf16_f32 v22, v28, v29
  v_cvt_pk_bf16_f32 v23, v30, v31
  v_pk_max_i16 v16, v16, 0
  s_waitcnt lgkmcnt(6)
  v_mfma_f32_32x32x16_bf16 v[48:63], v[236:239], v[128:131], v[48:63]
  ds_read_b64_tr_b16 v[92:93], v6 offset:8448
  ds_read_b64_tr_b16 v[94:95], v6 offset:9472
  v_pk_max_i16 v17, v17, 0
  v_pk_max_i16 v18, v18, 0
  v_pk_max_i16 v19, v19, 0
  v_pk_max_i16 v20, v20, 0
  v_pk_max_i16 v21, v21, 0
  v_mfma_f32_32x32x16_bf16 v[64:79], v[236:239], v[132:135], v[64:79]
  v_pk_max_i16 v22, v22, 0
  v_pk_max_i16 v23, v23, 0
  buffer_store_dwordx4 v[16:19], v14, s[28:31], s60 offen offset:0 sc1
  buffer_store_dwordx4 v[20:23], v14, s[28:31], s60 offen offset:1024 sc1
  v_cvt_pk_bf16_f32 v32, v32, v33
  s_waitcnt lgkmcnt(6)
  v_mfma_f32_32x32x16_bf16 v[48:63], v[228:231], v[136:139], v[48:63]
  ds_read_b64_tr_b16 v[84:85], v6 offset:12544
  ds_read_b64_tr_b16 v[86:87], v6 offset:13568
  v_cvt_pk_bf16_f32 v33, v34, v35
  v_cvt_pk_bf16_f32 v34, v36, v37
  v_cvt_pk_bf16_f32 v35, v38, v39
  v_cvt_pk_bf16_f32 v36, v40, v41
  v_cvt_pk_bf16_f32 v37, v42, v43
  v_mfma_f32_32x32x16_bf16 v[64:79], v[228:231], v[140:143], v[64:79]
  v_cvt_pk_bf16_f32 v38, v44, v45
  v_cvt_pk_bf16_f32 v39, v46, v47
  v_pk_max_i16 v32, v32, 0
  v_pk_max_i16 v33, v33, 0
  v_pk_max_i16 v34, v34, 0
  s_waitcnt lgkmcnt(6)
  v_mfma_f32_32x32x16_bf16 v[48:63], v[80:83], v[144:147], v[48:63]
  ds_read_b64_tr_b16 v[96:97], v6 offset:33024
  ds_read_b64_tr_b16 v[98:99], v6 offset:34048
  v_pk_max_i16 v35, v35, 0
  v_pk_max_i16 v36, v36, 0
  v_pk_max_i16 v37, v37, 0
  v_pk_max_i16 v38, v38, 0
  v_pk_max_i16 v39, v39, 0
  v_mfma_f32_32x32x16_bf16 v[64:79], v[80:83], v[148:151], v[64:79]
  buffer_store_dwordx4 v[32:35], v14, s[28:31], s61 offen offset:0 sc1
  buffer_store_dwordx4 v[36:39], v14, s[28:31], s61 offen offset:1024 sc1
  s_waitcnt lgkmcnt(6)
  v_mfma_f32_32x32x16_bf16 v[48:63], v[88:91], v[152:155], v[48:63]
  ds_read_b64_tr_b16 v[104:105], v6 offset:37120
  ds_read_b64_tr_b16 v[106:107], v6 offset:38144
  v_mfma_f32_32x32x16_bf16 v[64:79], v[88:91], v[156:159], v[64:79]
  s_waitcnt lgkmcnt(6)
  v_mfma_f32_32x32x16_bf16 v[48:63], v[92:95], v[160:163], v[48:63]
  ds_read_b64_tr_b16 v[108:109], v6 offset:41216
  ds_read_b64_tr_b16 v[110:111], v6 offset:42240
  v_mfma_f32_32x32x16_bf16 v[64:79], v[92:95], v[164:167], v[64:79]
  s_waitcnt lgkmcnt(6)
  v_mfma_f32_32x32x16_bf16 v[48:63], v[84:87], v[168:171], v[48:63]
  ds_read_b64_tr_b16 v[100:101], v6 offset:45312
  ds_read_b64_tr_b16 v[102:103], v6 offset:46336
  v_mfma_f32_32x32x16_bf16 v[64:79], v[84:87], v[172:175], v[64:79]
  s_waitcnt lgkmcnt(6)
  v_mfma_f32_32x32x16_bf16 v[48:63], v[96:99], v[176:179], v[48:63]
  v_mfma_f32_32x32x16_bf16 v[64:79], v[96:99], v[180:183], v[64:79]
  s_waitcnt lgkmcnt(4)
  v_mfma_f32_32x32x16_bf16 v[48:63], v[104:107], v[184:187], v[48:63]
  v_mfma_f32_32x32x16_bf16 v[64:79], v[104:107], v[188:191], v[64:79]
  s_waitcnt lgkmcnt(2)
  v_mfma_f32_32x32x16_bf16 v[48:63], v[108:111], v[192:195], v[48:63]
  v_mfma_f32_32x32x16_bf16 v[64:79], v[108:111], v[196:199], v[64:79]
  s_waitcnt lgkmcnt(0)
  v_mfma_f32_32x32x16_bf16 v[48:63], v[100:103], v[200:203], v[48:63]
  v_mfma_f32_32x32x16_bf16 v[64:79], v[100:103], v[204:207], v[64:79]
  s_nop 7
  s_nop 3
  v_cvt_pk_bf16_f32 v48, v48, v49
  v_cvt_pk_bf16_f32 v49, v50, v51
  v_cvt_pk_bf16_f32 v50, v52, v53
  v_cvt_pk_bf16_f32 v51, v54, v55
  v_cvt_pk_bf16_f32 v52, v56, v57
  v_cvt_pk_bf16_f32 v53, v58, v59
  v_cvt_pk_bf16_f32 v54, v60, v61
  v_cvt_pk_bf16_f32 v55, v62, v63
  v_pk_max_i16 v48, v48, 0
  v_pk_max_i16 v49, v49, 0
  v_pk_max_i16 v50, v50, 0
  v_pk_max_i16 v51, v51, 0
  v_pk_max_i16 v52, v52, 0
  v_pk_max_i16 v53, v53, 0
  v_pk_max_i16 v54, v54, 0
  v_pk_max_i16 v55, v55, 0
  buffer_store_dwordx4 v[48:51], v14, s[28:31], s60 offen offset:2048 sc1
  buffer_store_dwordx4 v[52:55], v14, s[28:31], s60 offen offset:3072 sc1
  v_cvt_pk_bf16_f32 v64, v64, v65
  v_cvt_pk_bf16_f32 v65, v66, v67
  v_cvt_pk_bf16_f32 v66, v68, v69
  v_cvt_pk_bf16_f32 v67, v70, v71
  v_cvt_pk_bf16_f32 v68, v72, v73
  v_cvt_pk_bf16_f32 v69, v74, v75
  v_cvt_pk_bf16_f32 v70, v76, v77
  v_cvt_pk_bf16_f32 v71, v78, v79
  v_pk_max_i16 v64, v64, 0
  v_pk_max_i16 v65, v65, 0
  v_pk_max_i16 v66, v66, 0
  v_pk_max_i16 v67, v67, 0
  v_pk_max_i16 v68, v68, 0
  v_pk_max_i16 v69, v69, 0
  v_pk_max_i16 v70, v70, 0
  v_pk_max_i16 v71, v71, 0
  buffer_store_dwordx4 v[64:67], v14, s[28:31], s61 offen offset:2048 sc1
  buffer_store_dwordx4 v[68:71], v14, s[28:31], s61 offen offset:3072 sc1
  s_barrier
  s_mov_b32 s63, 0
  s_waitcnt vmcnt(4)
  v_readlane_b32 s59, v5, 0
  v_readlane_b32 s62, v5, 1
L_tag:
  s_and_b32 s35, s59, s62
  s_cmp_lt_i32 s35, 0
  s_cbranch_scc1 L_tag_ok
  s_add_u32 s63, s63, 1
  s_cmp_ge_u32 s63, 200000
  s_cbranch_scc1 L_tag_ok
  s_load_dword s59, s[44:45], s64 glc
  s_load_dword s62, s[44:45], s65 glc
  s_waitcnt lgkmcnt(0)
  s_branch L_tag
L_tag_ok:
  s_atomic_add s78, s[72:73], 0
  s_mov_b32 s76, 0
  s_waitcnt vmcnt(0)
  s_atomic_add s79, s[72:73], 0
  s_bitcmp1_b32 s76, 1
  s_cbranch_scc0 L_wait0
L_ok0:
  buffer_load_dwordx4 v[16:19], v0, s[28:31], s4 offen offset:0 sc1
  buffer_load_dwordx4 v[48:51], v9, s[28:31], s4 offen offset:0 sc1
  buffer_load_dwordx4 v[52:55], v13, s[28:31], s4 offen offset:0 sc1
  buffer_load_dwordx4 v[56:59], v15, s[28:31], s4 offen offset:0 sc1
  s_bitcmp1_b32 s76, 3
  s_cbranch_scc0 L_wait1
L_ok1:
  buffer_load_dwordx4 v[20:23], v0, s[28:31], s5 offen offset:0 sc1
  buffer_load_dwordx4 v[60:63], v9, s[28:31], s5 offen offset:0 sc1
  buffer_load_dwordx4 v[64:67], v13, s[28:31], s5 offen offset:0 sc1
  buffer_load_dwordx4 v[68:71], v15, s[28:31], s5 offen offset:0 sc1
  s_bitcmp1_b32 s76, 5
  s_cbranch_scc0 L_wait2
L_ok2:
  buffer_load_dwordx4 v[24:27], v0, s[28:31], s6 offen offset:0 sc1
  s_barrier
  ds_read_b64_tr_b16 v[128:129], v253 offset:0
  ds_read_b64_tr_b16 v[130:131], v253 offset:1024
  ds_read_b64_tr_b16 v[132:133], v253 offset:256
  ds_read_b64_tr_b16 v[134:135], v253 offset:1280
  ds_read_b64_tr_b16 v[136:137], v253 offset:2048
  ds_read_b64_tr_b16 v[138:139], v253 offset:3072
  ds_read_b64_tr_b16 v[140:141], v253 offset:2304
  ds_read_b64_tr_b16 v[142:143], v253 offset:3328
  s_waitcnt vmcnt(8)
  s_waitcnt lgkmcnt(6)
  v_mfma_f32_32x32x16_bf16 v[208:223], v[128:131], v[16:19], 0
  ds_read_b64_tr_b16 v[144:145], v253 offset:4096
  ds_read_b64_tr_b16 v[146:147], v253 offset:5120
  s_waitcnt lgkmcnt(6)
  v_mfma_f32_32x32x16_bf16 v[224:239], v[132:135], v[16:19], 0
  ds_read_b64_tr_b16 v[148:149], v253 offset:4352
  ds_read_b64_tr_b16 v[150:151], v253 offset:5376
  s_bitcmp1_b32 s76, 7
  s_cbranch_scc0 L_wait3
L_ok3:
  buffer_load_dwordx4 v[28:31], v0, s[28:31], s7 offen offset:0 sc1
  buffer_load_dwordx4 v[72:75], v9, s[28:31], s6 offen offset:0 sc1
  s_waitcnt vmcnt(9)
  s_waitcnt lgkmcnt(6)
  v_mfma_f32_32x32x16_bf16 v[208:223], v[136:139], v[48:51], v[208:223]
  ds_read_b64_tr_b16 v[152:153], v253 offset:6144
  ds_read_b64_tr_b16 v[154:155], v253 offset:7168
  s_waitcnt lgkmcnt(6)
  v_mfma_f32_32x32x16_bf16 v[224:239], v[140:143], v[48:51], v[224:239]
  ds_read_b64_tr_b16 v[156:157], v253 offset:6400
  ds_read_b64_tr_b16 v[158:159], v253 offset:7424
  buffer_load_dwordx4 v[76:79], v13, s[28:31], s6 offen offset:0 sc1
  s_waitcnt vmcnt(9)
  s_waitcnt lgkmcnt(6)
  v_mfma_f32_32x32x16_bf16 v[208:223], v[144:147], v[52:55], v[208:223]
  ds_read_b64_tr_b16 v[160:161], v253 offset:8192
  ds_read_b64_tr_b16 v[162:163], v253 offset:9216
  s_waitcnt lgkmcnt(6)
  v_mfma_f32_32x32x16_bf16 v[224:239], v[148:151], v[52:55], v[224:239]
  ds_read_b64_tr_b16 v[164:165], v253 offset:8448
  ds_read_b64_tr_b16 v[166:167], v253 offset:9472
  buffer_load_dwordx4 v[80:83], v15, s[28:31], s6 offen offset:0 sc1
  s_waitcnt vmcnt(9)
  s_waitcnt lgkmcnt(6)
  v_mfma_f32_32x32x16_bf16 v[208:223], v[152:155], v[56:59], v[208:223]
  ds_read_b64_tr_b16 v[168:169], v253 offset:10240
  ds_read_b64_tr_b16 v[170:171], v253 offset:11264
  s_waitcnt lgkmcnt(6)
  v_mfma_f32_32x32x16_bf16 v[224:239], v[156:159], v[56:59], v[224:239]
  ds_read_b64_tr_b16 v[172:173], v253 offset:10496
  ds_read_b64_tr_b16 v[174:175], v253 offset:11520
  buffer_load_dwordx4 v[84:87], v9, s[28:31], s7 offen offset:0 sc1
  s_waitcnt vmcnt(9)
  s_waitcnt lgkmcnt(6)
  v_mfma_f32_32x32x16_bf16 v[208:223], v[160:163], v[20:23], v[208:223]
  ds_read_b64_tr_b16 v[176:177], v253 offset:12288
  ds_read_b64_tr_b16 v[178:179], v253 offset:13312
  s_waitcnt lgkmcnt(6)
  v_mfma_f32_32x32x16_bf16 v[224:239], v[164:167], v[20:23], v[224:239]
  ds_read_b64_tr_b16 v[180:181], v253 offset:12544
  ds_read_b64_tr_b16 v[182:183], v253 offset:13568
  s_bitcmp1_b32 s76, 9
  s_cbranch_scc0 L_wait4
L_ok4:
  buffer_load_dwordx4 v[32:35], v0, s[28:31], s32 offen offset:0 sc1
  s_waitcnt vmcnt(9)
  s_waitcnt lgkmcnt(6)
  v_mfma_f32_32x32x16_bf16 v[208:223], v[168:171], v[60:63], v[208:223]
  ds_read_b64_tr_b16 v[184:185], v253 offset:14336
  ds_read_b64_tr_b16 v[186:187], v253 offset:15360
  s_waitcnt lgkmcnt(6)
  v_mfma_f32_32x32x16_bf16 v[224:239], v[172:175], v[60:63], v[224:239]
  ds_read_b64_tr_b16 v[188:189], v253 offset:14592
  ds_read_b64_tr_b16 v[190:191], v253 offset:15616
  buffer_load_dwordx4 v[88:91], v13, s[28:31], s7 offen offset:0 sc1
  s_waitcnt vmcnt(9)
  s_waitcnt lgkmcnt(6)
  v_mfma_f32_32x32x16_bf16 v[208:223], v[176:179], v[64:67], v[208:223]
  ds_read_b64_tr_b16 v[128:129], v253 offset:32768
  ds_read_b64_tr_b16 v[130:131], v253 offset:33792
  s_waitcnt lgkmcnt(6)
  v_mfma_f32_32x32x16_bf16 v[224:239], v[180:183], v[64:67], v[224:239]
  ds_read_b64_tr_b16 v[132:133], v253 offset:33024
  ds_read_b64_tr_b16 v[134:135], v253 offset:34048
  buffer_load_dwordx4 v[92:95], v15, s[28:31], s7 offen offset:0 sc1
  s_waitcnt vmcnt(9)
  s_waitcnt lgkmcnt(6)
  v_mfma_f32_32x32x16_bf16 v[208:223], v[184:187], v[68:71], v[208:223]
  ds_read_b64_tr_b16 v[136:137], v253 offset:34816
  ds_read_b64_tr_b16 v[138:139], v253 offset:35840
  s_waitcnt lgkmcnt(6)
  v_mfma_f32_32x32x16_bf16 v[224:239], v[188:191], v[68:71], v[224:239]
  ds_read_b64_tr_b16 v[140:141], v253 offset:35072
  ds_read_b64_tr_b16 v[142:143], v253 offset:36096
  buffer_load_dwordx4 v[96:99], v9, s[28:31], s32 offen offset:0 sc1
  s_waitcnt vmcnt(9)
  s_waitcnt lgkmcnt(6)
  v_mfma_f32_32x32x16_bf16 v[208:223], v[128:131], v[24:27], v[208:223]
  ds_read_b64_tr_b16 v[144:145], v253 offset:36864
  ds_read_b64_tr_b16 v[146:147], v253 offset:37888
  s_waitcnt lgkmcnt(6)
  v_mfma_f32_32x32x16_bf16 v[224:239], v[132:135], v[24:27], v[224:239]
  ds_read_b64_tr_b16 v[148:149], v253 offset:37120
  ds_read_b64_tr_b16 v[150:151], v253 offset:38144
  s_bitcmp1_b32 s76, 11
  s_cbranch_scc0 L_wait5
L_ok5:
  buffer_load_dwordx4 v[36:39], v0, s[28:31], s33 offen offset:0 sc1
  s_waitcnt vmcnt(8)
  s_waitcnt lgkmcnt(6)
  v_mfma_f32_32x32x16_bf16 v[208:223], v[136:139], v[72:75], v[208:223]
  ds_read_b64_tr_b16 v[152:153], v253 offset:38912
  ds_read_b64_tr_b16 v[154:155], v253 offset:39936
  s_waitcnt lgkmcnt(6)
  v_mfma_f32_32x32x16_bf16 v[224:239], v[140:143], v[72:75], v[224:239]
  ds_read_b64_tr_b16 v[156:157], v253 offset:39168
  ds_read_b64_tr_b16 v[158:159], v253 offset:40192
  buffer_load_dwordx4 v[100:103], v13, s[28:31], s32 offen offset:0 sc1
  s_waitcnt vmcnt(8)
  s_waitcnt lgkmcnt(6)
  v_mfma_f32_32x32x16_bf16 v[208:223], v[144:147], v[76:79], v[208:223]
  ds_read_b64_tr_b16 v[160:161], v253 offset:40960
  ds_read_b64_tr_b16 v[162:163], v253 offset:41984
  s_waitcnt lgkmcnt(6)
  v_mfma_f32_32x32x16_bf16 v[224:239], v[148:151], v[76:79], v[224:239]
  ds_read_b64_tr_b16 v[164:165], v253 offset:41216
  ds_read_b64_tr_b16 v[166:167], v253 offset:42240
  buffer_load_dwordx4 v[104:107], v15, s[28:31], s32 offen offset:0 sc1
  s_waitcnt vmcnt(8)
  s_waitcnt lgkmcnt(6)
  v_mfma_f32_32x32x16_bf16 v[208:223], v[152:155], v[80:83], v[208:223]
  ds_read_b64_tr_b16 v[168:169], v253 offset:43008
  ds_read_b64_tr_b16 v[170:171], v253 offset:44032
  s_waitcnt lgkmcnt(6)
  v_mfma_f32_32x32x16_bf16 v[224:239], v[156:159], v[80:83], v[224:239]
  ds_read_b64_tr_b16 v[172:173], v253 offset:43264
  ds_read_b64_tr_b16 v[174:175], v253 offset:44288
  buffer_load_dwordx4 v[108:111], v9, s[28:31], s33 offen offset:0 sc1
  s_waitcnt lgkmcnt(6)
  v_mfma_f32_32x32x16_bf16 v[208:223], v[160:163], v[28:31], v[208:223]
  ds_read_b64_tr_b16 v[176:177], v253 offset:45056
  ds_read_b64_tr_b16 v[178:179], v253 offset:46080
  s_waitcnt lgkmcnt(6)
  v_mfma_f32_32x32x16_bf16 v[224:239], v[164:167], v[28:31], v[224:239]
  ds_read_b64_tr_b16 v[180:181], v253 offset:45312
  ds_read_b64_tr_b16 v[182:183], v253 offset:46336
  s_bitcmp1_b32 s76, 13
  s_cbranch_scc0 L_wait6
L_ok6:
  buffer_load_dwordx4 v[40:43], v0, s[28:31], s34 offen offset:0 sc1
  s_waitcnt vmcnt(9)
  s_waitcnt lgkmcnt(6)
  v_mfma_f32_32x32x16_bf16 v[208:223], v[168:171], v[84:87], v[208:223]
  ds_read_b64_tr_b16 v[184:185], v253 offset:47104
  ds_read_b64_tr_b16 v[186:187], v253 offset:48128
  s_waitcnt lgkmcnt(6)
  v_mfma_f32_32x32x16_bf16 v[224:239], v[172:175], v[84:87], v[224:239]
  ds_read_b64_tr_b16 v[188:189], v253 offset:47360
  ds_read_b64_tr_b16 v[190:191], v253 offset:48384
  buffer_load_dwordx4 v[112:115], v13, s[28:31], s33 offen offset:0 sc1
  s_waitcnt vmcnt(8)
  s_barrier
  s_waitcnt lgkmcnt(6)
  v_mfma_f32_32x32x16_bf16 v[208:223], v[176:179], v[88:91], v[208:223]
  ds_read_b64_tr_b16 v[128:129], v254 offset:0
  ds_read_b64_tr_b16 v[130:131], v254 offset:1024
  s_waitcnt lgkmcnt(6)
  v_mfma_f32_32x32x16_bf16 v[224:239], v[180:183], v[88:91], v[224:239]
  ds_read_b64_tr_b16 v[132:133], v254 offset:256
  ds_read_b64_tr_b16 v[134:135], v254 offset:1280
  buffer_load_dwordx4 v[116:119], v15, s[28:31], s33 offen offset:0 sc1
  s_waitcnt vmcnt(8)
  s_waitcnt lgkmcnt(6)
  v_mfma_f32_32x32x16_bf16 v[208:223], v[184:187], v[92:95], v[208:223]
  ds_read_b64_tr_b16 v[136:137], v254 offset:2048
  ds_read_b64_tr_b16 v[138:139], v254 offset:3072
  s_waitcnt lgkmcnt(6)
  v_mfma_f32_32x32x16_bf16 v[224:239], v[188:191], v[92:95], v[224:239]
  ds_read_b64_tr_b16 v[140:141], v254 offset:2304
  ds_read_b64_tr_b16 v[142:143], v254 offset:3328
  buffer_load_dwordx4 v[48:51], v9, s[28:31], s34 offen offset:0 sc1
  s_waitcnt lgkmcnt(6)
  v_mfma_f32_32x32x16_bf16 v[208:223], v[128:131], v[32:35], v[208:223]
  ds_read_b64_tr_b16 v[144:145], v254 offset:4096
  ds_read_b64_tr_b16 v[146:147], v254 offset:5120
  s_waitcnt lgkmcnt(6)
  v_mfma_f32_32x32x16_bf16 v[224:239], v[132:135], v[32:35], v[224:239]
  ds_read_b64_tr_b16 v[148:149], v254 offset:4352
  ds_read_b64_tr_b16 v[150:151], v254 offset:5376
  s_bitcmp1_b32 s76, 15
  s_cbranch_scc0 L_wait7
L_ok7:
  buffer_load_dwordx4 v[44:47], v0, s[28:31], s4 offen offset:2048 sc1
  s_waitcnt vmcnt(9)
  s_waitcnt lgkmcnt(6)
  v_mfma_f32_32x32x16_bf16 v[208:223], v[136:139], v[96:99], v[208:223]
  ds_read_b64_tr_b16 v[152:153], v254 offset:6144
  ds_read_b64_tr_b16 v[154:155], v254 offset:7168
  s_waitcnt lgkmcnt(6)
  v_mfma_f32_32x32x16_bf16 v[224:239], v[140:143], v[96:99], v[224:239]
  ds_read_b64_tr_b16 v[156:157], v254 offset:6400
  ds_read_b64_tr_b16 v[158:159], v254 offset:7424
  buffer_load_dwordx4 v[52:55], v13, s[28:31], s34 offen offset:0 sc1
  s_waitcnt vmcnt(8)
  s_waitcnt lgkmcnt(6)
  v_mfma_f32_32x32x16_bf16 v[208:223], v[144:147], v[100:103], v[208:223]
  ds_read_b64_tr_b16 v[160:161], v254 offset:8192
  ds_read_b64_tr_b16 v[162:163], v254 offset:9216
  s_waitcnt lgkmcnt(6)
  v_mfma_f32_32x32x16_bf16 v[224:239], v[148:151], v[100:103], v[224:239]
  ds_read_b64_tr_b16 v[164:165], v254 offset:8448
  ds_read_b64_tr_b16 v[166:167], v254 offset:9472
  buffer_load_dwordx4 v[56:59], v15, s[28:31], s34 offen offset:0 sc1
  s_waitcnt vmcnt(8)
  s_waitcnt lgkmcnt(6)
  v_mfma_f32_32x32x16_bf16 v[208:223], v[152:155], v[104:107], v[208:223]
  ds_read_b64_tr_b16 v[168:169], v254 offset:10240
  ds_read_b64_tr_b16 v[170:171], v254 offset:11264
  s_waitcnt lgkmcnt(6)
  v_mfma_f32_32x32x16_bf16 v[224:239], v[156:159], v[104:107], v[224:239]
  ds_read_b64_tr_b16 v[172:173], v254 offset:10496
  ds_read_b64_tr_b16 v[174:175], v254 offset:11520
  buffer_load_dwordx4 v[60:63], v9, s[28:31], s4 offen offset:2048 sc1
  s_waitcnt lgkmcnt(6)
  v_mfma_f32_32x32x16_bf16 v[208:223], v[160:163], v[36:39], v[208:223]
  ds_read_b64_tr_b16 v[176:177], v254 offset:12288
  ds_read_b64_tr_b16 v[178:179], v254 offset:13312
  s_waitcnt lgkmcnt(6)
  v_mfma_f32_32x32x16_bf16 v[224:239], v[164:167], v[36:39], v[224:239]
  ds_read_b64_tr_b16 v[180:181], v254 offset:12544
  ds_read_b64_tr_b16 v[182:183], v254 offset:13568
  s_bitcmp1_b32 s76, 17
  s_cbranch_scc0 L_wait8
L_ok8:
  buffer_load_dwordx4 v[16:19], v0, s[28:31], s5 offen offset:2048 sc1
  s_waitcnt vmcnt(9)
  s_waitcnt lgkmcnt(6)
  v_mfma_f32_32x32x16_bf16 v[208:223], v[168:171], v[108:111], v[208:223]
  ds_read_b64_tr_b16 v[184:185], v254 offset:14336
  ds_read_b64_tr_b16 v[186:187], v254 offset:15360
  s_waitcnt lgkmcnt(6)
  v_mfma_f32_32x32x16_bf16 v[224:239], v[172:175], v[108:111], v[224:239]
  ds_read_b64_tr_b16 v[188:189], v254 offset:14592
  ds_read_b64_tr_b16 v[190:191], v254 offset:15616
  buffer_load_dwordx4 v[64:67], v13, s[28:31], s4 offen offset:2048 sc1
  s_waitcnt vmcnt(8)
  s_barrier
  s_waitcnt lgkmcnt(6)
  v_mfma_f32_32x32x16_bf16 v[208:223], v[176:179], v[112:115], v[208:223]
  ds_read_b64_tr_b16 v[128:129], v252 offset:0
  ds_read_b64_tr_b16 v[130:131], v252 offset:1024
  s_waitcnt lgkmcnt(6)
  v_mfma_f32_32x32x16_bf16 v[224:239], v[180:183], v[112:115], v[224:239]
  ds_read_b64_tr_b16 v[132:133], v252 offset:256
  ds_read_b64_tr_b16 v[134:135], v252 offset:1280
  buffer_load_dwordx4 v[68:71], v15, s[28:31], s4 offen offset:2048 sc1
  s_waitcnt vmcnt(8)
  s_waitcnt lgkmcnt(6)
  v_mfma_f32_32x32x16_bf16 v[208:223], v[184:187], v[116:119], v[208:223]
  ds_read_b64_tr_b16 v[136:137], v252 offset:2048
  ds_read_b64_tr_b16 v[138:139], v252 offset:3072
  s_waitcnt lgkmcnt(6)
  v_mfma_f32_32x32x16_bf16 v[224:239], v[188:191], v[116:119], v[224:239]
  ds_read_b64_tr_b16 v[140:141], v252 offset:2304
  ds_read_b64_tr_b16 v[142:143], v252 offset:3328
  buffer_load_dwordx4 v[72:75], v9, s[28:31], s5 offen offset:2048 sc1
  s_waitcnt lgkmcnt(6)
  v_mfma_f32_32x32x16_bf16 v[208:223], v[128:131], v[40:43], v[208:223]
  ds_read_b64_tr_b16 v[144:145], v252 offset:4096
  ds_read_b64_tr_b16 v[146:147], v252 offset:5120
  s_waitcnt lgkmcnt(6)
  v_mfma_f32_32x32x16_bf16 v[224:239], v[132:135], v[40:43], v[224:239]
  ds_read_b64_tr_b16 v[148:149], v252 offset:4352
  ds_read_b64_tr_b16 v[150:151], v252 offset:5376
  s_bitcmp1_b32 s76, 19
  s_cbranch_scc0 L_wait9
L_ok9:
  buffer_load_dwordx4 v[20:23], v0, s[28:31], s6 offen offset:2048 sc1
  s_waitcnt vmcnt(9)
  s_waitcnt lgkmcnt(6)
  v_mfma_f32_32x32x16_bf16 v[208:223], v[136:139], v[48:51], v[208:223]
  ds_read_b64_tr_b16 v[152:153], v252 offset:6144
  ds_read_b64_tr_b16 v[154:155], v252 offset:7168
  s_waitcnt lgkmcnt(6)
  v_mfma_f32_32x32x16_bf16 v[224:239], v[140:143], v[48:51], v[224:239]
  ds_read_b64_tr_b16 v[156:157], v252 offset:6400
  ds_read_b64_tr_b16 v[158:159], v252 offset:7424
  buffer_load_dwordx4 v[76:79], v13, s[28:31], s5 offen offset:2048 sc1
  s_waitcnt vmcnt(8)
  s_waitcnt lgkmcnt(6)
  v_mfma_f32_32x32x16_bf16 v[208:223], v[144:147], v[52:55], v[208:223]
  ds_read_b64_tr_b16 v[160:161], v252 offset:8192
  ds_read_b64_tr_b16 v[162:163], v252 offset:9216
  s_waitcnt lgkmcnt(6)
  v_mfma_f32_32x32x16_bf16 v[224:239], v[148:151], v[52:55], v[224:239]
  ds_read_b64_tr_b16 v[164:165], v252 offset:8448
  ds_read_b64_tr_b16 v[166:167], v252 offset:9472
  buffer_load_dwordx4 v[80:83], v15, s[28:31], s5 offen offset:2048 sc1
  s_waitcnt vmcnt(8)
  s_waitcnt lgkmcnt(6)
  v_mfma_f32_32x32x16_bf16 v[208:223], v[152:155], v[56:59], v[208:223]
  ds_read_b64_tr_b16 v[168:169], v252 offset:10240
  ds_read_b64_tr_b16 v[170:171], v252 offset:11264
  s_waitcnt lgkmcnt(6)
  v_mfma_f32_32x32x16_bf16 v[224:239], v[156:159], v[56:59], v[224:239]
  ds_read_b64_tr_b16 v[172:173], v252 offset:10496
  ds_read_b64_tr_b16 v[174:175], v252 offset:11520
  buffer_load_dwordx4 v[84:87], v9, s[28:31], s6 offen offset:2048 sc1
  s_waitcnt lgkmcnt(6)
  v_mfma_f32_32x32x16_bf16 v[208:223], v[160:163], v[44:47], v[208:223]
  ds_read_b64_tr_b16 v[176:177], v252 offset:12288
  ds_read_b64_tr_b16 v[178:179], v252 offset:13312
  s_waitcnt lgkmcnt(6)
  v_mfma_f32_32x32x16_bf16 v[224:239], v[164:167], v[44:47], v[224:239]
  ds_read_b64_tr_b16 v[180:181], v252 offset:12544
  ds_read_b64_tr_b16 v[182:183], v252 offset:13568
  s_bitcmp1_b32 s76, 21
  s_cbranch_scc0 L_wait10
L_ok10:
  buffer_load_dwordx4 v[24:27], v0, s[28:31], s7 offen offset:2048 sc1
  s_waitcnt vmcnt(9)
  s_waitcnt lgkmcnt(6)
  v_mfma_f32_32x32x16_bf16 v[208:223], v[168:171], v[60:63], v[208:223]
  ds_read_b64_tr_b16 v[184:185], v252 offset:14336
  ds_read_b64_tr_b16 v[186:187], v252 offset:15360
  s_waitcnt lgkmcnt(6)
  v_mfma_f32_32x32x16_bf16 v[224:239], v[172:175], v[60:63], v[224:239]
  ds_read_b64_tr_b16 v[188:189], v252 offset:14592
  ds_read_b64_tr_b16 v[190:191], v252 offset:15616
  buffer_load_dwordx4 v[88:91], v13, s[28:31], s6 offen offset:2048 sc1
  s_waitcnt vmcnt(8)
  s_waitcnt lgkmcnt(6)
  v_mfma_f32_32x32x16_bf16 v[208:223], v[176:179], v[64:67], v[208:223]
  ds_read_b64_tr_b16 v[128:129], v252 offset:32768
  ds_read_b64_tr_b16 v[130:131], v252 offset:33792
  s_waitcnt lgkmcnt(6)
  v_mfma_f32_32x32x16_bf16 v[224:239], v[180:183], v[64:67], v[224:239]
  ds_read_b64_tr_b16 v[132:133], v252 offset:33024
  ds_read_b64_tr_b16 v[134:135], v252 offset:34048
  buffer_load_dwordx4 v[92:95], v15, s[28:31], s6 offen offset:2048 sc1
  s_waitcnt vmcnt(8)
  s_waitcnt lgkmcnt(6)
  v_mfma_f32_32x32x16_bf16 v[208:223], v[184:187], v[68:71], v[208:223]
  ds_read_b64_tr_b16 v[136:137], v252 offset:34816
  ds_read_b64_tr_b16 v[138:139], v252 offset:35840
  s_waitcnt lgkmcnt(6)
  v_mfma_f32_32x32x16_bf16 v[224:239], v[188:191], v[68:71], v[224:239]
  ds_read_b64_tr_b16 v[140:141], v252 offset:35072
  ds_read_b64_tr_b16 v[142:143], v252 offset:36096
  buffer_load_dwordx4 v[96:99], v9, s[28:31], s7 offen offset:2048 sc1
  s_waitcnt lgkmcnt(6)
  v_mfma_f32_32x32x16_bf16 v[208:223], v[128:131], v[16:19], v[208:223]
  ds_read_b64_tr_b16 v[144:145], v252 offset:36864
  ds_read_b64_tr_b16 v[146:147], v252 offset:37888
  s_waitcnt lgkmcnt(6)
  v_mfma_f32_32x32x16_bf16 v[224:239], v[132:135], v[16:19], v[224:239]
  ds_read_b64_tr_b16 v[148:149], v252 offset:37120
  ds_read_b64_tr_b16 v[150:151], v252 offset:38144
  s_bitcmp1_b32 s76, 23
  s_cbranch_scc0 L_wait11
L_ok11:
  buffer_load_dwordx4 v[28:31], v0, s[28:31], s32 offen offset:2048 sc1
  s_waitcnt vmcnt(9)
  s_waitcnt lgkmcnt(6)
  v_mfma_f32_32x32x16_bf16 v[208:223], v[136:139], v[72:75], v[208:223]
  ds_read_b64_tr_b16 v[152:153], v252 offset:38912
  ds_read_b64_tr_b16 v[154:155], v252 offset:39936
  s_waitcnt lgkmcnt(6)
  v_mfma_f32_32x32x16_bf16 v[224:239], v[140:143], v[72:75], v[224:239]
  ds_read_b64_tr_b16 v[156:157], v252 offset:39168
  ds_read_b64_tr_b16 v[158:159], v252 offset:40192
  buffer_load_dwordx4 v[100:103], v13, s[28:31], s7 offen offset:2048 sc1
  s_waitcnt vmcnt(8)
  s_waitcnt lgkmcnt(6)
  v_mfma_f32_32x32x16_bf16 v[208:223], v[144:147], v[76:79], v[208:223]
  ds_read_b64_tr_b16 v[160:161], v252 offset:40960
  ds_read_b64_tr_b16 v[162:163], v252 offset:41984
  s_waitcnt lgkmcnt(6)
  v_mfma_f32_32x32x16_bf16 v[224:239], v[148:151], v[76:79], v[224:239]
  ds_read_b64_tr_b16 v[164:165], v252 offset:41216
  ds_read_b64_tr_b16 v[166:167], v252 offset:42240
  buffer_load_dwordx4 v[104:107], v15, s[28:31], s7 offen offset:2048 sc1
  s_waitcnt vmcnt(8)
  s_waitcnt lgkmcnt(6)
  v_mfma_f32_32x32x16_bf16 v[208:223], v[152:155], v[80:83], v[208:223]
  ds_read_b64_tr_b16 v[168:169], v252 offset:43008
  ds_read_b64_tr_b16 v[170:171], v252 offset:44032
  s_waitcnt lgkmcnt(6)
  v_mfma_f32_32x32x16_bf16 v[224:239], v[156:159], v[80:83], v[224:239]
  ds_read_b64_tr_b16 v[172:173], v252 offset:43264
  ds_read_b64_tr_b16 v[174:175], v252 offset:44288
  buffer_load_dwordx4 v[108:111], v9, s[28:31], s32 offen offset:2048 sc1
  s_waitcnt lgkmcnt(6)
  v_mfma_f32_32x32x16_bf16 v[208:223], v[160:163], v[20:23], v[208:223]
  ds_read_b64_tr_b16 v[176:177], v252 offset:45056
  ds_read_b64_tr_b16 v[178:179], v252 offset:46080
  s_waitcnt lgkmcnt(6)
  v_mfma_f32_32x32x16_bf16 v[224:239], v[164:167], v[20:23], v[224:239]
  ds_read_b64_tr_b16 v[180:181], v252 offset:45312
  ds_read_b64_tr_b16 v[182:183], v252 offset:46336
  s_bitcmp1_b32 s76, 25
  s_cbranch_scc0 L_wait12
L_ok12:
  buffer_load_dwordx4 v[32:35], v0, s[28:31], s33 offen offset:2048 sc1
  s_waitcnt vmcnt(9)
  s_waitcnt lgkmcnt(6)
  v_mfma_f32_32x32x16_bf16 v[208:223], v[168:171], v[84:87], v[208:223]
  ds_read_b64_tr_b16 v[184:185], v252 offset:47104
  ds_read_b64_tr_b16 v[186:187], v252 offset:48128
  s_waitcnt lgkmcnt(6)
  v_mfma_f32_32x32x16_bf16 v[224:239], v[172:175], v[84:87], v[224:239]
  ds_read_b64_tr_b16 v[188:189], v252 offset:47360
  ds_read_b64_tr_b16 v[190:191], v252 offset:48384
  buffer_load_dwordx4 v[112:115], v13, s[28:31], s32 offen offset:2048 sc1
  s_waitcnt vmcnt(8)
  s_barrier
  s_waitcnt lgkmcnt(6)
  v_mfma_f32_32x32x16_bf16 v[208:223], v[176:179], v[88:91], v[208:223]
  ds_read_b64_tr_b16 v[128:129], v253 offset:0
  ds_read_b64_tr_b16 v[130:131], v253 offset:1024
  s_waitcnt lgkmcnt(6)
  v_mfma_f32_32x32x16_bf16 v[224:239], v[180:183], v[88:91], v[224:239]
  ds_read_b64_tr_b16 v[132:133], v253 offset:256
  ds_read_b64_tr_b16 v[134:135], v253 offset:1280
  buffer_load_dwordx4 v[116:119], v15, s[28:31], s32 offen offset:2048 sc1
  s_waitcnt vmcnt(8)
  s_waitcnt lgkmcnt(6)
  v_mfma_f32_32x32x16_bf16 v[208:223], v[184:187], v[92:95], v[208:223]
  ds_read_b64_tr_b16 v[136:137], v253 offset:2048
  ds_read_b64_tr_b16 v[138:139], v253 offset:3072
  s_waitcnt lgkmcnt(6)
  v_mfma_f32_32x32x16_bf16 v[224:239], v[188:191], v[92:95], v[224:239]
  ds_read_b64_tr_b16 v[140:141], v253 offset:2304
  ds_read_b64_tr_b16 v[142:143], v253 offset:3328
  buffer_load_dwordx4 v[48:51], v9, s[28:31], s33 offen offset:2048 sc1
  s_waitcnt lgkmcnt(6)
  v_mfma_f32_32x32x16_bf16 v[208:223], v[128:131], v[24:27], v[208:223]
  ds_read_b64_tr_b16 v[144:145], v253 offset:4096
  ds_read_b64_tr_b16 v[146:147], v253 offset:5120
  s_waitcnt lgkmcnt(6)
  v_mfma_f32_32x32x16_bf16 v[224:239], v[132:135], v[24:27], v[224:239]
  ds_read_b64_tr_b16 v[148:149], v253 offset:4352
  ds_read_b64_tr_b16 v[150:151], v253 offset:5376
  s_bitcmp1_b32 s76, 27
  s_cbranch_scc0 L_wait13
L_ok13:
  buffer_load_dwordx4 v[36:39], v0, s[28:31], s34 offen offset:2048 sc1
  s_waitcnt vmcnt(9)
  s_waitcnt lgkmcnt(6)
  v_mfma_f32_32x32x16_bf16 v[208:223], v[136:139], v[96:99], v[208:223]
  ds_read_b64_tr_b16 v[152:153], v253 offset:6144
  ds_read_b64_tr_b16 v[154:155], v253 offset:7168
  s_waitcnt lgkmcnt(6)
  v_mfma_f32_32x32x16_bf16 v[224:239], v[140:143], v[96:99], v[224:239]
  ds_read_b64_tr_b16 v[156:157], v253 offset:6400
  ds_read_b64_tr_b16 v[158:159], v253 offset:7424
  buffer_load_dwordx4 v[52:55], v13, s[28:31], s33 offen offset:2048 sc1
  s_waitcnt vmcnt(8)
  s_waitcnt lgkmcnt(6)
  v_mfma_f32_32x32x16_bf16 v[208:223], v[144:147], v[100:103], v[208:223]
  ds_read_b64_tr_b16 v[160:161], v253 offset:8192
  ds_read_b64_tr_b16 v[162:163], v253 offset:9216
  s_waitcnt lgkmcnt(6)
  v_mfma_f32_32x32x16_bf16 v[224:239], v[148:151], v[100:103], v[224:239]
  ds_read_b64_tr_b16 v[164:165], v253 offset:8448
  ds_read_b64_tr_b16 v[166:167], v253 offset:9472
  buffer_load_dwordx4 v[56:59], v15, s[28:31], s33 offen offset:2048 sc1
  s_waitcnt vmcnt(8)
  s_waitcnt lgkmcnt(6)
  v_mfma_f32_32x32x16_bf16 v[208:223], v[152:155], v[104:107], v[208:223]
  ds_read_b64_tr_b16 v[168:169], v253 offset:10240
  ds_read_b64_tr_b16 v[170:171], v253 offset:11264
  s_waitcnt lgkmcnt(6)
  v_mfma_f32_32x32x16_bf16 v[224:239], v[156:159], v[104:107], v[224:239]
  ds_read_b64_tr_b16 v[172:173], v253 offset:10496
  ds_read_b64_tr_b16 v[174:175], v253 offset:11520
  buffer_load_dwordx4 v[60:63], v9, s[28:31], s34 offen offset:2048 sc1
  s_waitcnt lgkmcnt(6)
  v_mfma_f32_32x32x16_bf16 v[208:223], v[160:163], v[28:31], v[208:223]
  ds_read_b64_tr_b16 v[176:177], v253 offset:12288
  ds_read_b64_tr_b16 v[178:179], v253 offset:13312
  s_waitcnt lgkmcnt(6)
  v_mfma_f32_32x32x16_bf16 v[224:239], v[164:167], v[28:31], v[224:239]
  ds_read_b64_tr_b16 v[180:181], v253 offset:12544
  ds_read_b64_tr_b16 v[182:183], v253 offset:13568
  s_waitcnt vmcnt(8)
  s_waitcnt lgkmcnt(6)
  v_mfma_f32_32x32x16_bf16 v[208:223], v[168:171], v[108:111], v[208:223]
  ds_read_b64_tr_b16 v[184:185], v253 offset:14336
  ds_read_b64_tr_b16 v[186:187], v253 offset:15360
  s_waitcnt lgkmcnt(6)
  v_mfma_f32_32x32x16_bf16 v[224:239], v[172:175], v[108:111], v[224:239]
  ds_read_b64_tr_b16 v[188:189], v253 offset:14592
  ds_read_b64_tr_b16 v[190:191], v253 offset:15616
  buffer_load_dwordx4 v[64:67], v13, s[28:31], s34 offen offset:2048 sc1
  s_waitcnt vmcnt(7)
  s_waitcnt lgkmcnt(6)
  v_mfma_f32_32x32x16_bf16 v[208:223], v[176:179], v[112:115], v[208:223]
  ds_read_b64_tr_b16 v[128:129], v253 offset:32768
  ds_read_b64_tr_b16 v[130:131], v253 offset:33792
  s_waitcnt lgkmcnt(6)
  v_mfma_f32_32x32x16_bf16 v[224:239], v[180:183], v[112:115], v[224:239]
  ds_read_b64_tr_b16 v[132:133], v253 offset:33024
  ds_read_b64_tr_b16 v[134:135], v253 offset:34048
  buffer_load_dwordx4 v[68:71], v15, s[28:31], s34 offen offset:2048 sc1
  s_waitcnt vmcnt(7)
  s_waitcnt lgkmcnt(6)
  v_mfma_f32_32x32x16_bf16 v[208:223], v[184:187], v[116:119], v[208:223]
  ds_read_b64_tr_b16 v[136:137], v253 offset:34816
  ds_read_b64_tr_b16 v[138:139], v253 offset:35840
  s_waitcnt lgkmcnt(6)
  v_mfma_f32_32x32x16_bf16 v[224:239], v[188:191], v[116:119], v[224:239]
  ds_read_b64_tr_b16 v[140:141], v253 offset:35072
  ds_read_b64_tr_b16 v[142:143], v253 offset:36096
  s_waitcnt lgkmcnt(6)
  v_mfma_f32_32x32x16_bf16 v[208:223], v[128:131], v[32:35], v[208:223]
  ds_read_b64_tr_b16 v[144:145], v253 offset:36864
  ds_read_b64_tr_b16 v[146:147], v253 offset:37888
  s_waitcnt lgkmcnt(6)
  v_mfma_f32_32x32x16_bf16 v[224:239], v[132:135], v[32:35], v[224:239]
  ds_read_b64_tr_b16 v[148:149], v253 offset:37120
  ds_read_b64_tr_b16 v[150:151], v253 offset:38144
  s_waitcnt vmcnt(6)
  s_waitcnt lgkmcnt(6)
  v_mfma_f32_32x32x16_bf16 v[208:223], v[136:139], v[48:51], v[208:223]
  ds_read_b64_tr_b16 v[152:153], v253 offset:38912
  ds_read_b64_tr_b16 v[154:155], v253 offset:39936
  s_waitcnt lgkmcnt(6)
  v_mfma_f32_32x32x16_bf16 v[224:239], v[140:143], v[48:51], v[224:239]
  ds_read_b64_tr_b16 v[156:157], v253 offset:39168
  ds_read_b64_tr_b16 v[158:159], v253 offset:40192
  s_waitcnt vmcnt(4)
  s_waitcnt lgkmcnt(6)
  v_mfma_f32_32x32x16_bf16 v[208:223], v[144:147], v[52:55], v[208:223]
  ds_read_b64_tr_b16 v[160:161], v253 offset:40960
  ds_read_b64_tr_b16 v[162:163], v253 offset:41984
  s_waitcnt lgkmcnt(6)
  v_mfma_f32_32x32x16_bf16 v[224:239], v[148:151], v[52:55], v[224:239]
  ds_read_b64_tr_b16 v[164:165], v253 offset:41216
  ds_read_b64_tr_b16 v[166:167], v253 offset:42240
  s_waitcnt vmcnt(3)
  s_waitcnt lgkmcnt(6)
  v_mfma_f32_32x32x16_bf16 v[208:223], v[152:155], v[56:59], v[208:223]
  ds_read_b64_tr_b16 v[168:169], v253 offset:43008
  ds_read_b64_tr_b16 v[170:171], v253 offset:44032
  s_waitcnt lgkmcnt(6)
  v_mfma_f32_32x32x16_bf16 v[224:239], v[156:159], v[56:59], v[224:239]
  ds_read_b64_tr_b16 v[172:173], v253 offset:43264
  ds_read_b64_tr_b16 v[174:175], v253 offset:44288
  s_waitcnt lgkmcnt(6)
  v_mfma_f32_32x32x16_bf16 v[208:223], v[160:163], v[36:39], v[208:223]
  ds_read_b64_tr_b16 v[176:177], v253 offset:45056
  ds_read_b64_tr_b16 v[178:179], v253 offset:46080
  s_waitcnt lgkmcnt(6)
  v_mfma_f32_32x32x16_bf16 v[224:239], v[164:167], v[36:39], v[224:239]
  ds_read_b64_tr_b16 v[180:181], v253 offset:45312
  ds_read_b64_tr_b16 v[182:183], v253 offset:46336
  s_waitcnt vmcnt(2)
  s_waitcnt lgkmcnt(6)
  v_mfma_f32_32x32x16_bf16 v[208:223], v[168:171], v[60:63], v[208:223]
  ds_read_b64_tr_b16 v[184:185], v253 offset:47104
  ds_read_b64_tr_b16 v[186:187], v253 offset:48128
  s_waitcnt lgkmcnt(6)
  v_mfma_f32_32x32x16_bf16 v[224:239], v[172:175], v[60:63], v[224:239]
  ds_read_b64_tr_b16 v[188:189], v253 offset:47360
  ds_read_b64_tr_b16 v[190:191], v253 offset:48384
  s_waitcnt vmcnt(1)
  s_waitcnt lgkmcnt(6)
  v_mfma_f32_32x32x16_bf16 v[208:223], v[176:179], v[64:67], v[208:223]
  s_waitcnt lgkmcnt(4)
  v_mfma_f32_32x32x16_bf16 v[224:239], v[180:183], v[64:67], v[224:239]
  s_waitcnt vmcnt(0)
  s_waitcnt lgkmcnt(2)
  v_mfma_f32_32x32x16_bf16 v[208:223], v[184:187], v[68:71], v[208:223]
  s_waitcnt lgkmcnt(0)
  v_mfma_f32_32x32x16_bf16 v[224:239], v[188:191], v[68:71], v[224:239]
  v_xor_b32 v2, 16, v10
  v_xor_b32 v3, 32, v10
  v_xor_b32 v4, 48, v10
  v_xor_b32 v5, 128, v10
  v_xor_b32 v6, 144, v10
  v_xor_b32 v7, 160, v10
  v_xor_b32 v8, 176, v10
  v_xor_b32 v9, 16, v11
  s_add_u32 s59, s56, 7168
  s_nop 1
  ds_write_b128 v10, v[208:211]
  ds_write_b128 v2, v[212:215]
  ds_write_b128 v3, v[216:219]
  ds_write_b128 v4, v[220:223]
  ds_write_b128 v5, v[224:227]
  ds_write_b128 v6, v[228:231]
  ds_write_b128 v7, v[232:235]
  ds_write_b128 v8, v[236:239]
  s_waitcnt lgkmcnt(0)
  s_barrier
  ds_read_b128 v[16:19], v11 offset:0
  ds_read_b128 v[20:23], v9 offset:0
  ds_read_b128 v[24:27], v11 offset:16384
  ds_read_b128 v[28:31], v9 offset:16384
  ds_read_b128 v[32:35], v11 offset:2048
  ds_read_b128 v[36:39], v9 offset:2048
  ds_read_b128 v[40:43], v11 offset:18432
  ds_read_b128 v[44:47], v9 offset:18432
  s_waitcnt lgkmcnt(4)
  v_add_f32 v16, v16, v24
  v_add_f32 v17, v17, v25
  v_add_f32 v18, v18, v26
  v_add_f32 v19, v19, v27
  v_add_f32 v20, v20, v28
  v_add_f32 v21, v21, v29
  v_add_f32 v22, v22, v30
  v_add_f32 v23, v23, v31
  v_cvt_pk_bf16_f32 v48, v16, v17
  v_cvt_pk_bf16_f32 v49, v18, v19
  v_cvt_pk_bf16_f32 v50, v20, v21
  v_cvt_pk_bf16_f32 v51, v22, v23
  buffer_store_dwordx4 v[48:51], v12, s[20:23], s56 offen sc1
  s_waitcnt lgkmcnt(0)
  v_add_f32 v32, v32, v40
  v_add_f32 v33, v33, v41
  v_add_f32 v34, v34, v42
  v_add_f32 v35, v35, v43
  v_add_f32 v36, v36, v44
  v_add_f32 v37, v37, v45
  v_add_f32 v38, v38, v46
  v_add_f32 v39, v39, v47
  v_cvt_pk_bf16_f32 v52, v32, v33
  v_cvt_pk_bf16_f32 v53, v34, v35
  v_cvt_pk_bf16_f32 v54, v36, v37
  v_cvt_pk_bf16_f32 v55, v38, v39
  buffer_store_dwordx4 v[52:55], v12, s[20:23], s59 offen sc1
  s_endpgm
L_wait0:
  s_load_dword s76, s[74:75], 0 glc
  s_add_u32 s63, s63, 1
  s_waitcnt lgkmcnt(0)
  s_bitcmp1_b32 s76, 1
  s_cbranch_scc1 L_ok0
  s_cmp_lt_u32 s63, 200000
  s_cbranch_scc1 L_wait0
  s_branch L_ok0
L_wait1:
  s_load_dword s76, s[74:75], 0 glc
  s_add_u32 s63, s63, 1
  s_waitcnt lgkmcnt(0)
  s_bitcmp1_b32 s76, 3
  s_cbranch_scc1 L_ok1
  s_cmp_lt_u32 s63, 200000
  s_cbranch_scc1 L_wait1
  s_branch L_ok1
L_wait2:
  s_load_dword s76, s[74:75], 0 glc
  s_add_u32 s63, s63, 1
  s_waitcnt lgkmcnt(0)
  s_bitcmp1_b32 s76, 5
  s_cbranch_scc1 L_ok2
  s_cmp_lt_u32 s63, 200000
  s_cbranch_scc1 L_wait2
  s_branch L_ok2
L_wait3:
  s_load_dword s76, s[74:75], 0 glc
  s_add_u32 s63, s63, 1
  s_waitcnt lgkmcnt(0)
  s_bitcmp1_b32 s76, 7
  s_cbranch_scc1 L_ok3
  s_cmp_lt_u32 s63, 200000
  s_cbranch_scc1 L_wait3
  s_branch L_ok3
L_wait4:
  s_load_dword s76, s[74:75], 0 glc
  s_add_u32 s63, s63, 1
  s_waitcnt lgkmcnt(0)
  s_bitcmp1_b32 s76, 9
  s_cbranch_scc1 L_ok4
  s_cmp_lt_u32 s63, 200000
  s_cbranch_scc1 L_wait4
  s_branch L_ok4
L_wait5:
  s_load_dword s76, s[74:75], 0 glc
  s_add_u32 s63, s63, 1
  s_waitcnt lgkmcnt(0)
  s_bitcmp1_b32 s76, 11
  s_cbranch_scc1 L_ok5
  s_cmp_lt_u32 s63, 200000
  s_cbranch_scc1 L_wait5
  s_branch L_ok5
L_wait6:
  s_load_dword s76, s[74:75], 0 glc
  s_add_u32 s63, s63, 1
  s_waitcnt lgkmcnt(0)
  s_bitcmp1_b32 s76, 13
  s_cbranch_scc1 L_ok6
  s_cmp_lt_u32 s63, 200000
  s_cbranch_scc1 L_wait6
  s_branch L_ok6
L_wait7:
  s_load_dword s76, s[74:75], 0 glc
  s_add_u32 s63, s63, 1
  s_waitcnt lgkmcnt(0)
  s_bitcmp1_b32 s76, 15
  s_cbranch_scc1 L_ok7
  s_cmp_lt_u32 s63, 200000
  s_cbranch_scc1 L_wait7
  s_branch L_ok7
L_wait8:
  s_load_dword s76, s[74:75], 0 glc
  s_add_u32 s63, s63, 1
  s_waitcnt lgkmcnt(0)
  s_bitcmp1_b32 s76, 17
  s_cbranch_scc1 L_ok8
  s_cmp_lt_u32 s63, 200000
  s_cbranch_scc1 L_wait8
  s_branch L_ok8
L_wait9:
  s_load_dword s76, s[74:75], 0 glc
  s_add_u32 s63, s63, 1
  s_waitcnt lgkmcnt(0)
  s_bitcmp1_b32 s76, 19
  s_cbranch_scc1 L_ok9
  s_cmp_lt_u32 s63, 200000
  s_cbranch_scc1 L_wait9
  s_branch L_ok9
L_wait10:
  s_load_dword s76, s[74:75], 0 glc
  s_add_u32 s63, s63, 1
  s_waitcnt lgkmcnt(0)
  s_bitcmp1_b32 s76, 21
  s_cbranch_scc1 L_ok10
  s_cmp_lt_u32 s63, 200000
  s_cbranch_scc1 L_wait10
  s_branch L_ok10
L_wait11:
  s_load_dword s76, s[74:75], 0 glc
  s_add_u32 s63, s63, 1
  s_waitcnt lgkmcnt(0)
  s_bitcmp1_b32 s76, 23
  s_cbranch_scc1 L_ok11
  s_cmp_lt_u32 s63, 200000
  s_cbranch_scc1 L_wait11
  s_branch L_ok11
L_wait12:
  s_load_dword s76, s[74:75], 0 glc
  s_add_u32 s63, s63, 1
  s_waitcnt lgkmcnt(0)
  s_bitcmp1_b32 s76, 25
  s_cbranch_scc1 L_ok12
  s_cmp_lt_u32 s63, 200000
  s_cbranch_scc1 L_wait12
  s_branch L_ok12
L_wait13:
  s_load_dword s76, s[74:75], 0 glc
  s_add_u32 s63, s63, 1
  s_waitcnt lgkmcnt(0)
  s_bitcmp1_b32 s76, 27
  s_cbranch_scc1 L_ok13
  s_cmp_lt_u32 s63, 200000
  s_cbranch_scc1 L_wait13
  s_branch L_ok13
L_codeend:
  .fill 256, 4, 0xbf800000
.section .rodata,"a"
.p2align 6
.amdhsa_kernel standalone__dense_activation_relu__prompt_kernel
  .amdhsa_next_free_vgpr 256
  .amdhsa_next_free_sgpr 96
  .amdhsa_accum_offset 256
  .amdhsa_group_segment_fixed_size 0
  .amdhsa_kernarg_size 48
  .amdhsa_user_sgpr_count 2
  .amdhsa_user_sgpr_kernarg_segment_ptr 1
  .amdhsa_system_sgpr_workgroup_id_x 1
.end_amdhsa_kernel
```
